```python
import torch

def _softmax(x, axis=-1):
    return torch.softmax(x, dim=axis)
def _gelu(x):
    return torch.nn.functional.gelu(x, approximate="tanh")
def _silu(x):
    return torch.nn.functional.silu(x)
def _sigmoid(x):
    return torch.sigmoid(x)
def _layernorm(x, axis=-1, eps=1e-5):
    m = x.mean(dim=axis, keepdim=True)
    v = x.var(dim=axis, keepdim=True, unbiased=False)
    return (x - m) / torch.sqrt(v + eps)
def _scatter_add(tgt, idx, src, axis=0):
    return tgt.clone().index_add_(axis, idx, src)
def _segment_sum(src, seg, n):
    out = torch.zeros((n,) + src.shape[1:], dtype=src.dtype)
    return out.index_add_(0, seg, src)
def _pad(x, pw):
    flat = tuple(v for pair in reversed(pw) for v in pair)
    return torch.nn.functional.pad(x, flat)

kernel_name = 'gated_mix__sliding_local_dilated__dense_activation_mish__prompt'

def setup_inputs():

    _w = (lambda a: (lambda t: t.to(torch.bfloat16) if t.is_floating_point() else t)(torch.as_tensor(a)))
    def _A_setup():
        B, S, D = 1, 2048, 640
        return {
            "x": _w((lambda *s: torch.randn(*s, dtype=torch.bfloat16) * 0.05)(B, S, D)),
            "wqkv": _w((lambda *s: torch.randn(*s, dtype=torch.bfloat16) * 0.8)(D, 3 * D)),
            "wo": _w((lambda *s: torch.randn(*s, dtype=torch.bfloat16) * 0.05)(D, D)),
        }
    _A_in = _A_setup()

    def _B_setup():
        B, S, D, F = 1, 2048, 640, 1728
        return {
            "x": _w((lambda *s: torch.randn(*s, dtype=torch.bfloat16) * 0.05)(B, S, D)),
            "w1": _w((lambda *s: torch.randn(*s, dtype=torch.bfloat16) * 12.8)(D, F) * (D ** -0.5)),
            "b1": _w((lambda *s: torch.randn(*s, dtype=torch.bfloat16) * 0.8)(F)),
            "w2": _w((lambda *s: torch.randn(*s, dtype=torch.bfloat16) * 0.8)(F, D) * (F ** -0.5)),
        }
    _B_in = _B_setup()

    return {
        "A_x": _A_in["x"],
        "A_wqkv": _A_in["wqkv"],
        "A_wo": _A_in["wo"],
        "B_x": _B_in["x"],
        "B_w1": _B_in["w1"],
        "B_b1": _B_in["b1"],
        "B_w2": _B_in["w2"],
        "gate_w": _w((lambda *s: torch.randn(*s, dtype=torch.bfloat16) * 0.05)(640) * 16.0),
    }

def reference(A_x, A_wqkv, A_wo, B_x, B_w1, B_b1, B_w2, gate_w):
    def _A_ref(x, wqkv, wo):
        B, S, D = x.shape
        H = 32; Dh = D // H
        W, dil = 8, 2
        qkv = (lambda x, *d: x.permute(*d))((x @ wqkv).reshape(B, S, 3, H, Dh), 2, 0, 3, 1, 4)
        q, k, v = qkv[0], qkv[1], qkv[2]
        scale = Dh ** -0.5
        pos = torch.arange(S)
        off = torch.arange(W) * dil
        idx = pos[:, None] - off[None, :]
        mask = idx >= 0
        idx_c = torch.where(mask, idx, 0).reshape(-1)
        kg = k[:, :, idx_c, :].reshape(B, H, S, W, Dh)
        vg = v[:, :, idx_c, :].reshape(B, H, S, W, Dh)
        logits = torch.einsum("bhsd,bhswd->bhsw", q, kg) * scale
        logits = torch.where(mask[None, None, :, :], logits, -1e9)
        attn = _softmax(logits, axis=-1)
        o = torch.einsum("bhsw,bhswd->bhsd", attn, vg)
        return (lambda x, *d: x.permute(*d))(o, 0, 2, 1, 3).reshape(B, S, D) @ wo

    def _B_ref(x, w1, b1, w2):
        h = torch.einsum("bsd,df->bsf", x, w1) + b1
        sp = torch.log1p(torch.exp(-torch.abs(h))) + torch.where(h > 0, h, torch.zeros_like(h))
        act = h * torch.tanh(sp)
        return torch.einsum("bsf,fd->bsd", act, w2)

    x = A_x
    g = _sigmoid((x * gate_w).sum(-1, keepdims=True))
    a = _A_ref(x, A_wqkv, A_wo)
    b = _B_ref(x, B_w1, B_b1, B_w2)
    return g * a + (1 - g) * b
```

```asm
; @launch grid=(256,1,1) block=(768,1,1) lds=163840
.amdgcn_target "amdgcn-amd-amdhsa--gfx950"
.text
.globl gated_mix__sliding_local_dilated__dense_activation_mish__prompt_kernel
.p2align 8
.type gated_mix__sliding_local_dilated__dense_activation_mish__prompt_kernel,@function
gated_mix__sliding_local_dilated__dense_activation_mish__prompt_kernel:
    s_cmp_ge_u32 s2, 256
    s_cbranch_scc1 gated_mix__sliding_local_dilated__dense_activation_mish__prompt_kernel_exit
    s_load_dwordx4 s[96:99], s[0:1], 64
    s_load_dwordx4 s[4:7], s[0:1], 0
    s_load_dwordx2 s[8:9], s[0:1], 16
    s_load_dwordx2 s[10:11], s[0:1], 80
    s_load_dwordx4 s[12:15], s[0:1], 32
    s_load_dwordx4 s[16:19], s[0:1], 48
    v_lshrrev_b32 v1, 6, v0
    v_and_b32 v153, 63, v0
    v_readfirstlane_b32 s50, v1
    v_lshlrev_b32 v152, 4, v153
    s_and_b32 s60, s2, 7
    s_lshr_b32 s61, s2, 3
    s_and_b32 s62, s60, 1
    s_lshl_b32 s62, s62, 3
    s_and_b32 s63, s61, 7
    s_add_u32 s54, s62, s63
    s_lshl_b32 s52, s54, 7
    s_lshr_b32 s62, s60, 1
    s_lshr_b32 s63, s61, 3
    s_lshr_b32 s51, s63, 1
    s_and_b32 s63, s63, 1
    s_lshl_b32 s62, s62, 1
    s_add_u32 s53, s62, s63
    s_mul_i32 s55, s53, 14
    s_lshr_b32 s62, s53, 2
    s_lshl_b32 s62, s62, 1
    s_sub_u32 s55, s55, s62
    s_and_b32 s62, s53, 3
    s_cmp_eq_u32 s62, 3
    s_cselect_b32 s56, 1, 0
    s_and_b32 s57, s50, 1
    s_lshr_b32 s58, s50, 1
    s_mov_b32 s64, 3456
    s_cmp_eq_u32 s51, 0
    s_cselect_b32 s64, 3840, s64
    s_cselect_b32 s65, 1152, 0
    s_mul_i32 s62, s53, 160
    s_mul_i32 s63, s55, 32
    s_cselect_b32 s66, s62, s63
    s_lshl_b32 s62, s56, 1
    s_sub_u32 s62, 14, s62
    s_cmp_eq_u32 s51, 0
    s_cselect_b32 s67, 64, s62
    s_lshl_b32 s68, s64, 6
    s_lshl_b32 s3, s54, 4
    s_lshl_b32 s60, s51, 3
    s_add_u32 s3, s3, s60
    s_add_u32 s3, s3, s53
    s_cmp_ge_u32 s50, 4
    s_cbranch_scc1 gated_mix__sliding_local_dilated__dense_activation_mish__prompt_kernel_compute
    s_setprio 3
    v_mov_b32 v100, 0
    s_lshl_b32 s60, s50, 4
    s_mul_i32 s72, s60, s64
    s_lshl_b32 s61, s64, 1
    s_add_u32 s73, s72, s61
    s_lshl_b32 s62, s64, 3
    s_add_u32 s74, s72, s62
    s_add_u32 s75, s74, s61
    s_lshl_b32 s63, s64, 2
    s_add_u32 s76, s72, s63
    s_add_u32 s77, s76, s61
    s_add_u32 s78, s74, s63
    s_add_u32 s79, s78, s61
    s_lshl_b32 s60, s50, 5
    s_add_u32 s60, s60, s52
    s_mul_i32 s20, s60, 1280
    s_sub_u32 s60, s52, 16
    s_lshl_b32 s61, s50, 3
    s_add_u32 s60, s60, s61
    s_mul_i32 s22, s60, 1280
    s_cmp_eq_u32 s52, 0
    s_cselect_b32 s22, 0x80000000, s22
    s_mov_b32 s90, -1
    s_mov_b32 s91, 0x0fffffff
    s_mul_i32 s71, s50, 7680
    s_add_u32 s71, s71, 18432
    s_lshl_b32 s23, s50, 12
    s_add_u32 s23, s23, 2048
    s_lshl_b32 s48, s50, 10
    s_lshl_b32 s60, s51, 1
    s_add_u32 s60, s60, s50
    s_cmp_lt_u32 s60, 2
    s_cselect_b32 s70, 1, 0
    s_cmp_eq_u32 s51, 0
    s_cselect_b32 s62, 12, 14
    s_and_b32 s63, s53, 1
    s_cselect_b32 s63, s63, 0
    s_cmp_eq_u32 s51, 0
    s_cselect_b32 s63, s63, 0
    s_lshl_b32 s60, s62, 1
    v_lshrrev_b32 v8, 1, v153
    v_cmp_le_u32 vcc, s62, v8
    v_subrev_u32 v9, s62, v8
    v_xor_b32 v9, 1, v9
    v_cndmask_b32 v9, v8, v9, vcc
    v_cndmask_b32 v10, 0, 1, vcc
    v_lshrrev_b32 v11, 2, v9
    v_mul_u32_u24 v11, s65, v11
    v_lshl_add_u32 v11, v9, 5, v11
    s_lshl_b32 s61, s63, 5
    v_add_u32 v11, s61, v11
    v_subrev_u32 v12, 24, v8
    v_cmp_le_u32 vcc, 3, v12
    v_subrev_u32 v13, 3, v12
    s_nop 0
    v_cndmask_b32 v12, v12, v13, vcc
    v_cndmask_b32 v13, 0, 1, vcc
    v_mul_u32_u24 v12, 1280, v12
    s_lshl_b32 s61, s63, 7
    s_sub_u32 s61, 128, s61
    v_add_u32 v12, s61, v12
    v_cmp_le_u32 vcc, s60, v8
    s_nop 1
    v_cndmask_b32 v11, v11, v12, vcc
    v_cndmask_b32 v10, v10, v13, vcc
    v_mul_u32_u24 v10, s64, v10
    v_and_b32 v12, 1, v153
    v_lshl_add_u32 v11, v12, 4, v11
    v_add3_u32 v9, v10, v11, s66
    s_cmp_eq_u32 s51, 0
    s_cselect_b32 s60, 64, s60
    v_cmp_le_u32 vcc, s60, v8
    v_mov_b32 v10, 0x80000000
    s_nop 0
    v_cndmask_b32 v9, v9, v10, vcc
    v_cmp_le_u32 vcc, s62, v8
    v_subrev_u32 v12, s62, v8
    s_nop 0
    v_cndmask_b32 v12, v8, v12, vcc
    v_cmp_le_u32 vcc, s67, v12
    v_lshrrev_b32 v11, 3, v153
    s_nop 0
    v_cndmask_b32 v4, v9, v10, vcc
    v_mul_u32_u24 v11, 1280, v11
    v_and_b32 v9, 7, v153
    v_lshrrev_b32 v10, 4, v153
    v_xor_b32 v9, v9, v10
    v_lshl_add_u32 v5, v9, 4, v11
    v_xor_b32 v6, 64, v5
    v_mov_b32 v7, v5
    s_cmp_eq_u32 s50, 1
    s_cbranch_scc0 gated_mix__sliding_local_dilated__dense_activation_mish__prompt_kernel_h0
    v_mov_b32 v7, v6
gated_mix__sliding_local_dilated__dense_activation_mish__prompt_kernel_h0:
    s_waitcnt lgkmcnt(0)
    s_mov_b32 s36, s4
    s_and_b32 s37, s5, 0xffff
    s_mov_b32 s38, 2621440
    s_mov_b32 s39, 0x20000
    s_mov_b32 s26, 2211840
    s_cmp_eq_u32 s51, 0
    s_cselect_b32 s24, s6, s12
    s_cselect_b32 s25, s7, s13
    s_cselect_b32 s26, 2457600, s26
    s_and_b32 s25, s25, 0xffff
    s_mov_b32 s27, 0x20000
    s_mov_b32 s28, s10
    s_and_b32 s29, s11, 0xffff
    s_mov_b32 s30, 16777216
    s_mov_b32 s31, 0x20000
    s_mov_b32 s40, s18
    s_and_b32 s41, s19, 0xffff
    s_mov_b32 s42, 1280
    s_mov_b32 s43, 0x20000
    s_mov_b32 s21, 0
    s_lshl_b32 s67, s64, 6
    s_lshr_b32 s60, s2, 6
    s_mul_i32 s60, s60, 5
    s_lshr_b32 s60, s60, 1
    s_and_b32 s61, s54, 7
    s_add_u32 s60, s60, s61
    s_lshr_b32 s61, s61, 2
    s_add_u32 s60, s60, s61
    s_sub_u32 s61, s60, 10
    s_cmp_ge_u32 s60, 10
    s_cselect_b32 s60, s61, s60
    s_sub_u32 s61, s60, 10
    s_cmp_ge_u32 s60, 10
    s_cselect_b32 s60, s61, s60
    s_mul_i32 s60, s60, 1
    s_add_u32 s45, s60, 0
    s_mov_b32 s44, s45
    s_lshl_b32 s60, s44, 7
    s_add_u32 s20, s20, s60
    s_add_u32 s22, s22, s60
    s_mul_i32 s60, s44, s67
    s_add_u32 s72, s72, s60
    s_add_u32 s73, s73, s60
    s_add_u32 s74, s74, s60
    s_add_u32 s75, s75, s60
    s_add_u32 s76, s76, s60
    s_add_u32 s77, s77, s60
    s_add_u32 s78, s78, s60
    s_add_u32 s79, s79, s60
    s_mov_b32 s66, 0
    s_and_b32 s63, s3, 31
    s_lshl_b32 s60, s50, 5
    s_add_u32 s63, s63, s60
    s_mov_b32 s34, 2211840
    s_cmp_lt_u32 s63, 20
    s_cselect_b32 s32, s8, s16
    s_cselect_b32 s33, s9, s17
    s_cselect_b32 s34, 819200, s34
    s_cselect_b32 s60, 0, 20
    s_sub_u32 s60, s63, s60
    s_mul_i32 s60, s60, 40960
    s_lshr_b32 s61, s3, 5
    s_mul_i32 s61, s61, 160
    s_add_u32 s62, s60, s61
    s_cmp_lt_u32 s63, 74
    s_cselect_b32 s62, s62, 0x80000000
    s_lshl_b32 s60, s55, 5
    s_cmp_eq_u32 s50, 3
    s_cselect_b32 s32, s14, s32
    s_cselect_b32 s33, s15, s33
    s_cselect_b32 s34, 3456, s34
    s_cselect_b32 s62, s60, s62
    s_and_b32 s33, s33, 0xffff
    s_mov_b32 s35, 0x20000
    s_lshr_b32 s60, s3, 5
    s_mul_i32 s60, s60, 74
    s_add_u32 s60, s60, s63
    s_mul_i32 s60, s60, 5120
    s_add_u32 s64, s60, 10485760
    s_cmp_lt_u32 s63, 74
    s_cselect_b32 s64, s64, 0x80000000
    s_add_u32 s65, s64, 4096
    s_mul_i32 s63, s50, 5120
    s_add_u32 s63, s63, 147456
    s_lshl_b32 s60, s53, 4
    s_add_u32 s60, s60, s52
    s_lshl_b32 s61, s50, 2
    s_add_u32 s49, s60, s61
    s_cmp_eq_u32 s70, 1
    s_cbranch_scc1 gated_mix__sliding_local_dilated__dense_activation_mish__prompt_kernel_hA
    s_cmp_eq_u32 s51, 0
    s_cbranch_scc1 gated_mix__sliding_local_dilated__dense_activation_mish__prompt_kernel_hC
    s_branch gated_mix__sliding_local_dilated__dense_activation_mish__prompt_kernel_hB
gated_mix__sliding_local_dilated__dense_activation_mish__prompt_kernel_dma0:
    s_add_u32 s66, s66, 1
    s_add_u32 s46, s44, 1
    s_cmp_eq_u32 s46, 10
    s_cselect_b32 s46, 0, s46
    s_cmp_eq_u32 s66, 0
    s_cselect_b32 s46, s45, s46
    s_sub_u32 s47, s46, s44
    s_mov_b32 s44, s46
    s_mul_i32 s46, s47, s67
    s_lshl_b32 s47, s47, 7
    s_add_u32 s68, s23, s21
    s_add_u32 s69, s20, 0
    s_add_u32 m0, s68, 0
    s_nop 0
    buffer_load_dwordx4 v5, s[36:39], s69 offen lds
    s_add_u32 s69, s20, 10240
    s_add_u32 m0, s68, 1024
    s_nop 0
    buffer_load_dwordx4 v6, s[36:39], s69 offen lds
    s_add_u32 s69, s20, 20480
    s_add_u32 m0, s68, 2048
    s_nop 0
    buffer_load_dwordx4 v5, s[36:39], s69 offen lds
    s_add_u32 s69, s20, 30720
    s_add_u32 m0, s68, 3072
    s_nop 0
    buffer_load_dwordx4 v6, s[36:39], s69 offen lds
    s_add_u32 s68, s71, s21
    s_mov_b64 exec, s[90:91]
    s_add_u32 m0, s68, 0
    s_nop 0
    buffer_load_dwordx4 v4, s[24:27], s72 offen lds
    s_add_u32 s72, s72, s46
    s_add_u32 m0, s68, 960
    s_nop 0
    buffer_load_dwordx4 v4, s[24:27], s73 offen lds
    s_add_u32 s73, s73, s46
    s_add_u32 m0, s68, 1920
    s_nop 0
    buffer_load_dwordx4 v4, s[24:27], s74 offen lds
    s_add_u32 s74, s74, s46
    s_add_u32 m0, s68, 2880
    s_nop 0
    buffer_load_dwordx4 v4, s[24:27], s75 offen lds
    s_add_u32 s75, s75, s46
    s_add_u32 m0, s68, 3840
    s_nop 0
    buffer_load_dwordx4 v4, s[24:27], s76 offen lds
    s_add_u32 s76, s76, s46
    s_add_u32 m0, s68, 4800
    s_nop 0
    buffer_load_dwordx4 v4, s[24:27], s77 offen lds
    s_add_u32 s77, s77, s46
    s_add_u32 m0, s68, 5760
    s_nop 0
    buffer_load_dwordx4 v4, s[24:27], s78 offen lds
    s_add_u32 s78, s78, s46
    s_add_u32 m0, s68, 6720
    s_nop 0
    buffer_load_dwordx4 v4, s[24:27], s79 offen lds
    s_add_u32 s79, s79, s46
    s_mov_b64 exec, -1
    s_add_u32 s20, s20, s47
    s_add_u32 s21, s21, 49152
    s_cmp_eq_u32 s21, 147456
    s_cselect_b32 s21, 0, s21
    s_setpc_b64 s[88:89]
gated_mix__sliding_local_dilated__dense_activation_mish__prompt_kernel_dma1:
    s_add_u32 s66, s66, 1
    s_add_u32 s46, s44, 1
    s_cmp_eq_u32 s46, 10
    s_cselect_b32 s46, 0, s46
    s_cmp_eq_u32 s66, 0
    s_cselect_b32 s46, s45, s46
    s_sub_u32 s47, s46, s44
    s_mov_b32 s44, s46
    s_mul_i32 s46, s47, s67
    s_lshl_b32 s47, s47, 7
    s_add_u32 s68, s23, s21
    s_add_u32 s69, s20, 0
    s_add_u32 m0, s68, 0
    s_nop 0
    buffer_load_dwordx4 v5, s[36:39], s69 offen lds
    s_add_u32 s69, s20, 10240
    s_add_u32 m0, s68, 1024
    s_nop 0
    buffer_load_dwordx4 v6, s[36:39], s69 offen lds
    s_add_u32 s69, s20, 20480
    s_add_u32 m0, s68, 2048
    s_nop 0
    buffer_load_dwordx4 v5, s[36:39], s69 offen lds
    s_add_u32 s69, s20, 30720
    s_add_u32 m0, s68, 3072
    s_nop 0
    buffer_load_dwordx4 v6, s[36:39], s69 offen lds
    s_add_u32 m0, s48, s21
    s_nop 0
    buffer_load_dwordx4 v7, s[36:39], s22 offen lds
    s_add_u32 s22, s22, s47
    s_add_u32 s68, s71, s21
    s_mov_b64 exec, s[90:91]
    s_add_u32 m0, s68, 0
    s_nop 0
    buffer_load_dwordx4 v4, s[24:27], s72 offen lds
    s_add_u32 s72, s72, s46
    s_add_u32 m0, s68, 960
    s_nop 0
    buffer_load_dwordx4 v4, s[24:27], s73 offen lds
    s_add_u32 s73, s73, s46
    s_add_u32 m0, s68, 1920
    s_nop 0
    buffer_load_dwordx4 v4, s[24:27], s74 offen lds
    s_add_u32 s74, s74, s46
    s_add_u32 m0, s68, 2880
    s_nop 0
    buffer_load_dwordx4 v4, s[24:27], s75 offen lds
    s_add_u32 s75, s75, s46
    s_add_u32 m0, s68, 3840
    s_nop 0
    buffer_load_dwordx4 v4, s[24:27], s76 offen lds
    s_add_u32 s76, s76, s46
    s_add_u32 m0, s68, 4800
    s_nop 0
    buffer_load_dwordx4 v4, s[24:27], s77 offen lds
    s_add_u32 s77, s77, s46
    s_add_u32 m0, s68, 5760
    s_nop 0
    buffer_load_dwordx4 v4, s[24:27], s78 offen lds
    s_add_u32 s78, s78, s46
    s_add_u32 m0, s68, 6720
    s_nop 0
    buffer_load_dwordx4 v4, s[24:27], s79 offen lds
    s_add_u32 s79, s79, s46
    s_mov_b64 exec, -1
    s_add_u32 s20, s20, s47
    s_add_u32 s21, s21, 49152
    s_cmp_eq_u32 s21, 147456
    s_cselect_b32 s21, 0, s21
    s_setpc_b64 s[88:89]
gated_mix__sliding_local_dilated__dense_activation_mish__prompt_kernel_hA:
    s_call_b64 s[88:89], gated_mix__sliding_local_dilated__dense_activation_mish__prompt_kernel_dma1
    s_call_b64 s[88:89], gated_mix__sliding_local_dilated__dense_activation_mish__prompt_kernel_dma1
    s_waitcnt vmcnt(13)
    s_barrier
    s_call_b64 s[88:89], gated_mix__sliding_local_dilated__dense_activation_mish__prompt_kernel_dma1
    s_cmp_eq_u32 s50, 3
    s_cbranch_scc1 gated_mix__sliding_local_dilated__dense_activation_mish__prompt_kernel_ea3_0
    v_add_u32 v9, 0, v153
    v_mul_u32_u24 v10, 205, v9
    v_lshrrev_b32 v10, 11, v10
    v_mul_u32_u24 v11, 10, v10
    v_sub_u32 v11, v9, v11
    v_mul_u32_u24 v10, 1280, v10
    v_lshl_add_u32 v10, v11, 4, v10
    s_add_u32 m0, s63, 0
    s_nop 0
    buffer_load_dwordx4 v10, s[32:35], s62 offen lds
    v_add_u32 v9, 64, v153
    v_mul_u32_u24 v10, 205, v9
    v_lshrrev_b32 v10, 11, v10
    v_mul_u32_u24 v11, 10, v10
    v_sub_u32 v11, v9, v11
    v_mul_u32_u24 v10, 1280, v10
    v_lshl_add_u32 v10, v11, 4, v10
    s_add_u32 m0, s63, 1024
    s_nop 0
    buffer_load_dwordx4 v10, s[32:35], s62 offen lds
    v_add_u32 v9, 128, v153
    v_mul_u32_u24 v10, 205, v9
    v_lshrrev_b32 v10, 11, v10
    v_mul_u32_u24 v11, 10, v10
    v_sub_u32 v11, v9, v11
    v_mul_u32_u24 v10, 1280, v10
    v_lshl_add_u32 v10, v11, 4, v10
    s_add_u32 m0, s63, 2048
    s_nop 0
    buffer_load_dwordx4 v10, s[32:35], s62 offen lds
    v_add_u32 v9, 192, v153
    v_mul_u32_u24 v10, 205, v9
    v_lshrrev_b32 v10, 11, v10
    v_mul_u32_u24 v11, 10, v10
    v_sub_u32 v11, v9, v11
    v_mul_u32_u24 v10, 1280, v10
    v_lshl_add_u32 v10, v11, 4, v10
    s_add_u32 m0, s63, 3072
    s_nop 0
    buffer_load_dwordx4 v10, s[32:35], s62 offen lds
    v_add_u32 v9, 256, v153
    v_mul_u32_u24 v10, 205, v9
    v_lshrrev_b32 v10, 11, v10
    v_mul_u32_u24 v11, 10, v10
    v_sub_u32 v11, v9, v11
    v_mul_u32_u24 v10, 1280, v10
    v_lshl_add_u32 v10, v11, 4, v10
    s_add_u32 m0, s63, 4096
    s_nop 0
    buffer_load_dwordx4 v10, s[32:35], s62 offen lds
    s_branch gated_mix__sliding_local_dilated__dense_activation_mish__prompt_kernel_ea_end0
gated_mix__sliding_local_dilated__dense_activation_mish__prompt_kernel_ea3_0:
    s_mov_b32 m0, 162880
    s_mov_b64 exec, 0xffffffff
    buffer_load_dwordx4 v152, s[32:35], s62 offen lds
    s_lshr_b32 s60, s3, 4
    s_lshl_b32 s60, s60, 8
    s_and_b32 s61, s3, 15
    s_lshl_b32 s61, s61, 2
    s_add_u32 s60, s60, s61
    s_add_u32 s60, s60, 15204352
    v_mov_b32 v9, 0
    s_mov_b64 exec, 1
    buffer_store_dword v9, v9, s[28:31], s60 offen sc1
    s_lshl_b32 s60, s3, 2
    s_add_u32 s60, s60, 15269888
    buffer_store_dword v9, v9, s[28:31], s60 offen sc1
    buffer_store_dword v9, v9, s[28:31], s64 offen
    buffer_store_dword v9, v9, s[28:31], s64 offen
    s_mov_b64 exec, -1
gated_mix__sliding_local_dilated__dense_activation_mish__prompt_kernel_ea_end0:
    s_waitcnt vmcnt(18)
    s_barrier
    s_call_b64 s[88:89], gated_mix__sliding_local_dilated__dense_activation_mish__prompt_kernel_dma1
    s_waitcnt vmcnt(18)
    s_barrier
    s_call_b64 s[88:89], gated_mix__sliding_local_dilated__dense_activation_mish__prompt_kernel_dma1
    s_waitcnt vmcnt(13)
    s_barrier
    s_call_b64 s[88:89], gated_mix__sliding_local_dilated__dense_activation_mish__prompt_kernel_dma1
    v_lshrrev_b32 v8, 2, v153
    v_mul_u32_u24 v8, 160, v8
    v_and_b32 v9, 3, v153
    v_lshl_add_u32 v8, v9, 3, v8
    v_add_u32 v8, s63, v8
    ds_read_b64_tr_b16 v[72:73], v8 offset:0
    ds_read_b64_tr_b16 v[74:75], v8 offset:2560
    ds_read_b64_tr_b16 v[76:77], v8 offset:32
    ds_read_b64_tr_b16 v[78:79], v8 offset:2592
    ds_read_b64_tr_b16 v[80:81], v8 offset:64
    ds_read_b64_tr_b16 v[82:83], v8 offset:2624
    ds_read_b64_tr_b16 v[84:85], v8 offset:96
    ds_read_b64_tr_b16 v[86:87], v8 offset:2656
    ds_read_b64_tr_b16 v[88:89], v8 offset:128
    ds_read_b64_tr_b16 v[90:91], v8 offset:2688
    s_waitcnt lgkmcnt(0)
    buffer_store_dwordx4 v[72:75], v152, s[28:31], s64 offen offset:0 sc1
    buffer_store_dwordx4 v[76:79], v152, s[28:31], s64 offen offset:1024 sc1
    buffer_store_dwordx4 v[80:83], v152, s[28:31], s64 offen offset:2048 sc1
    buffer_store_dwordx4 v[84:87], v152, s[28:31], s64 offen offset:3072 sc1
    buffer_store_dwordx4 v[88:91], v152, s[28:31], s65 offen sc1
    s_waitcnt vmcnt(18)
    s_barrier
    s_call_b64 s[88:89], gated_mix__sliding_local_dilated__dense_activation_mish__prompt_kernel_dma1
    s_waitcnt vmcnt(18)
    s_barrier
    s_call_b64 s[88:89], gated_mix__sliding_local_dilated__dense_activation_mish__prompt_kernel_dma1
    s_waitcnt vmcnt(13)
    s_barrier
    s_cmp_eq_u32 s50, 1
    s_cbranch_scc0 gated_mix__sliding_local_dilated__dense_activation_mish__prompt_kernel_nowfhA
    v_mov_b32 v9, 1
    v_mov_b32 v10, 0
    s_lshl_b32 s60, s3, 2
    s_add_u32 s60, s60, 15269888
    s_mov_b64 exec, 1
    buffer_store_dword v9, v10, s[28:31], s60 offen sc1
    s_mov_b64 exec, -1
gated_mix__sliding_local_dilated__dense_activation_mish__prompt_kernel_nowfhA:
    s_call_b64 s[88:89], gated_mix__sliding_local_dilated__dense_activation_mish__prompt_kernel_dma1
    s_cmp_eq_u32 s50, 0
    s_cbranch_scc0 gated_mix__sliding_local_dilated__dense_activation_mish__prompt_kernel_nodbghA
    s_mov_b32 s32, s98
    s_and_b32 s33, s99, 0xffff
    s_mov_b32 s34, 256
    s_mov_b32 s35, 0x20000
    s_and_b32 s60, s2, 7
    s_lshr_b32 s61, s2, 3
    s_lshl_b32 s56, s60, 2
    s_lshr_b32 s62, s61, 3
    s_add_u32 s56, s56, s62
    s_and_b32 s57, s61, 7
    s_lshr_b32 s58, s56, 1
    s_lshl_b32 s60, s58, 4
    s_lshl_b32 s61, s57, 5
    s_sub_u32 s61, s61, 16
    v_min_u32 v102, 11, v153
    v_lshlrev_b32 v100, 2, v102
    v_cmp_gt_u32 vcc, 4, v102
    v_mov_b32 v103, s61
    v_mov_b32 v104, s60
    v_cndmask_b32 v103, v103, v104, vcc
    v_add_u32 v100, v100, v103
    buffer_load_dword v101, v100, s[32:35], 0 offen sc1
gated_mix__sliding_local_dilated__dense_activation_mish__prompt_kernel_nodbghA:
    s_waitcnt vmcnt(13)
    s_barrier
    s_call_b64 s[88:89], gated_mix__sliding_local_dilated__dense_activation_mish__prompt_kernel_dma1
    s_waitcnt vmcnt(13)
    s_barrier
    s_cmp_eq_u32 s50, 0
    s_cbranch_scc1 gated_mix__sliding_local_dilated__dense_activation_mish__prompt_kernel_htail
    s_waitcnt vmcnt(0)
    s_barrier
    s_endpgm
gated_mix__sliding_local_dilated__dense_activation_mish__prompt_kernel_hC:
    s_call_b64 s[88:89], gated_mix__sliding_local_dilated__dense_activation_mish__prompt_kernel_dma0
    s_call_b64 s[88:89], gated_mix__sliding_local_dilated__dense_activation_mish__prompt_kernel_dma0
    s_waitcnt vmcnt(12)
    s_barrier
    s_call_b64 s[88:89], gated_mix__sliding_local_dilated__dense_activation_mish__prompt_kernel_dma0
    s_cmp_eq_u32 s50, 3
    s_cbranch_scc1 gated_mix__sliding_local_dilated__dense_activation_mish__prompt_kernel_ea3_1
    v_add_u32 v9, 0, v153
    v_mul_u32_u24 v10, 205, v9
    v_lshrrev_b32 v10, 11, v10
    v_mul_u32_u24 v11, 10, v10
    v_sub_u32 v11, v9, v11
    v_mul_u32_u24 v10, 1280, v10
    v_lshl_add_u32 v10, v11, 4, v10
    s_add_u32 m0, s63, 0
    s_nop 0
    buffer_load_dwordx4 v10, s[32:35], s62 offen lds
    v_add_u32 v9, 64, v153
    v_mul_u32_u24 v10, 205, v9
    v_lshrrev_b32 v10, 11, v10
    v_mul_u32_u24 v11, 10, v10
    v_sub_u32 v11, v9, v11
    v_mul_u32_u24 v10, 1280, v10
    v_lshl_add_u32 v10, v11, 4, v10
    s_add_u32 m0, s63, 1024
    s_nop 0
    buffer_load_dwordx4 v10, s[32:35], s62 offen lds
    v_add_u32 v9, 128, v153
    v_mul_u32_u24 v10, 205, v9
    v_lshrrev_b32 v10, 11, v10
    v_mul_u32_u24 v11, 10, v10
    v_sub_u32 v11, v9, v11
    v_mul_u32_u24 v10, 1280, v10
    v_lshl_add_u32 v10, v11, 4, v10
    s_add_u32 m0, s63, 2048
    s_nop 0
    buffer_load_dwordx4 v10, s[32:35], s62 offen lds
    v_add_u32 v9, 192, v153
    v_mul_u32_u24 v10, 205, v9
    v_lshrrev_b32 v10, 11, v10
    v_mul_u32_u24 v11, 10, v10
    v_sub_u32 v11, v9, v11
    v_mul_u32_u24 v10, 1280, v10
    v_lshl_add_u32 v10, v11, 4, v10
    s_add_u32 m0, s63, 3072
    s_nop 0
    buffer_load_dwordx4 v10, s[32:35], s62 offen lds
    v_add_u32 v9, 256, v153
    v_mul_u32_u24 v10, 205, v9
    v_lshrrev_b32 v10, 11, v10
    v_mul_u32_u24 v11, 10, v10
    v_sub_u32 v11, v9, v11
    v_mul_u32_u24 v10, 1280, v10
    v_lshl_add_u32 v10, v11, 4, v10
    s_add_u32 m0, s63, 4096
    s_nop 0
    buffer_load_dwordx4 v10, s[32:35], s62 offen lds
    s_branch gated_mix__sliding_local_dilated__dense_activation_mish__prompt_kernel_ea_end1
gated_mix__sliding_local_dilated__dense_activation_mish__prompt_kernel_ea3_1:
    s_mov_b32 m0, 162880
    s_mov_b64 exec, 0xffffffff
    buffer_load_dwordx4 v152, s[32:35], s62 offen lds
    s_lshr_b32 s60, s3, 4
    s_lshl_b32 s60, s60, 8
    s_and_b32 s61, s3, 15
    s_lshl_b32 s61, s61, 2
    s_add_u32 s60, s60, s61
    s_add_u32 s60, s60, 15204352
    v_mov_b32 v9, 0
    s_mov_b64 exec, 1
    buffer_store_dword v9, v9, s[28:31], s60 offen sc1
    s_lshl_b32 s60, s3, 2
    s_add_u32 s60, s60, 15269888
    buffer_store_dword v9, v9, s[28:31], s60 offen sc1
    buffer_store_dword v9, v9, s[28:31], s64 offen
    buffer_store_dword v9, v9, s[28:31], s64 offen
    s_mov_b64 exec, -1
gated_mix__sliding_local_dilated__dense_activation_mish__prompt_kernel_ea_end1:
    s_waitcnt vmcnt(17)
    s_barrier
    s_call_b64 s[88:89], gated_mix__sliding_local_dilated__dense_activation_mish__prompt_kernel_dma0
    s_waitcnt vmcnt(17)
    s_barrier
    s_call_b64 s[88:89], gated_mix__sliding_local_dilated__dense_activation_mish__prompt_kernel_dma0
    s_waitcnt vmcnt(12)
    s_barrier
    s_cmp_eq_u32 s50, 3
    s_cbranch_scc0 gated_mix__sliding_local_dilated__dense_activation_mish__prompt_kernel_nordyhC
    s_mov_b32 s32, s98
    s_and_b32 s33, s99, 0xffff
    s_mov_b32 s34, 256
    s_mov_b32 s35, 0x20000
    v_mov_b32 v9, 1
    v_mov_b32 v10, 0
    s_mov_b64 exec, 1
    buffer_store_byte v9, v10, s[32:35], s3 offen sc1
    s_mov_b64 exec, -1
gated_mix__sliding_local_dilated__dense_activation_mish__prompt_kernel_nordyhC:
    s_call_b64 s[88:89], gated_mix__sliding_local_dilated__dense_activation_mish__prompt_kernel_dma0
    v_lshrrev_b32 v8, 2, v153
    v_mul_u32_u24 v8, 160, v8
    v_and_b32 v9, 3, v153
    v_lshl_add_u32 v8, v9, 3, v8
    v_add_u32 v8, s63, v8
    ds_read_b64_tr_b16 v[72:73], v8 offset:0
    ds_read_b64_tr_b16 v[74:75], v8 offset:2560
    ds_read_b64_tr_b16 v[76:77], v8 offset:32
    ds_read_b64_tr_b16 v[78:79], v8 offset:2592
    ds_read_b64_tr_b16 v[80:81], v8 offset:64
    ds_read_b64_tr_b16 v[82:83], v8 offset:2624
    ds_read_b64_tr_b16 v[84:85], v8 offset:96
    ds_read_b64_tr_b16 v[86:87], v8 offset:2656
    ds_read_b64_tr_b16 v[88:89], v8 offset:128
    ds_read_b64_tr_b16 v[90:91], v8 offset:2688
    s_waitcnt lgkmcnt(0)
    buffer_store_dwordx4 v[72:75], v152, s[28:31], s64 offen offset:0 sc1
    buffer_store_dwordx4 v[76:79], v152, s[28:31], s64 offen offset:1024 sc1
    buffer_store_dwordx4 v[80:83], v152, s[28:31], s64 offen offset:2048 sc1
    buffer_store_dwordx4 v[84:87], v152, s[28:31], s64 offen offset:3072 sc1
    buffer_store_dwordx4 v[88:91], v152, s[28:31], s65 offen sc1
    s_waitcnt vmcnt(17)
    s_barrier
    s_call_b64 s[88:89], gated_mix__sliding_local_dilated__dense_activation_mish__prompt_kernel_dma0
    s_waitcnt vmcnt(17)
    s_barrier
    s_call_b64 s[88:89], gated_mix__sliding_local_dilated__dense_activation_mish__prompt_kernel_dma0
    s_waitcnt vmcnt(12)
    s_barrier
    s_cmp_eq_u32 s50, 1
    s_cbranch_scc0 gated_mix__sliding_local_dilated__dense_activation_mish__prompt_kernel_nowfhC
    v_mov_b32 v9, 1
    v_mov_b32 v10, 0
    s_lshl_b32 s60, s3, 2
    s_add_u32 s60, s60, 15269888
    s_mov_b64 exec, 1
    buffer_store_dword v9, v10, s[28:31], s60 offen sc1
    s_mov_b64 exec, -1
gated_mix__sliding_local_dilated__dense_activation_mish__prompt_kernel_nowfhC:
    s_call_b64 s[88:89], gated_mix__sliding_local_dilated__dense_activation_mish__prompt_kernel_dma0
    s_cmp_eq_u32 s50, 0
    s_cbranch_scc0 gated_mix__sliding_local_dilated__dense_activation_mish__prompt_kernel_nodbghC
    s_mov_b32 s32, s98
    s_and_b32 s33, s99, 0xffff
    s_mov_b32 s34, 256
    s_mov_b32 s35, 0x20000
    s_and_b32 s60, s2, 7
    s_lshr_b32 s61, s2, 3
    s_lshl_b32 s56, s60, 2
    s_lshr_b32 s62, s61, 3
    s_add_u32 s56, s56, s62
    s_and_b32 s57, s61, 7
    s_lshr_b32 s58, s56, 1
    s_lshl_b32 s60, s58, 4
    s_lshl_b32 s61, s57, 5
    s_sub_u32 s61, s61, 16
    v_min_u32 v102, 11, v153
    v_lshlrev_b32 v100, 2, v102
    v_cmp_gt_u32 vcc, 4, v102
    v_mov_b32 v103, s61
    v_mov_b32 v104, s60
    v_cndmask_b32 v103, v103, v104, vcc
    v_add_u32 v100, v100, v103
    buffer_load_dword v101, v100, s[32:35], 0 offen sc1
gated_mix__sliding_local_dilated__dense_activation_mish__prompt_kernel_nodbghC:
    s_waitcnt vmcnt(12)
    s_barrier
    s_call_b64 s[88:89], gated_mix__sliding_local_dilated__dense_activation_mish__prompt_kernel_dma0
    s_waitcnt vmcnt(12)
    s_barrier
    s_cmp_eq_u32 s50, 0
    s_cbranch_scc1 gated_mix__sliding_local_dilated__dense_activation_mish__prompt_kernel_htail
    s_waitcnt vmcnt(0)
    s_barrier
    s_endpgm
gated_mix__sliding_local_dilated__dense_activation_mish__prompt_kernel_hB:
    s_call_b64 s[88:89], gated_mix__sliding_local_dilated__dense_activation_mish__prompt_kernel_dma0
    s_call_b64 s[88:89], gated_mix__sliding_local_dilated__dense_activation_mish__prompt_kernel_dma0
    s_waitcnt vmcnt(12)
    s_barrier
    s_call_b64 s[88:89], gated_mix__sliding_local_dilated__dense_activation_mish__prompt_kernel_dma0
    s_cmp_eq_u32 s50, 3
    s_cbranch_scc1 gated_mix__sliding_local_dilated__dense_activation_mish__prompt_kernel_ea3_2
    v_add_u32 v9, 0, v153
    v_mul_u32_u24 v10, 205, v9
    v_lshrrev_b32 v10, 11, v10
    v_mul_u32_u24 v11, 10, v10
    v_sub_u32 v11, v9, v11
    v_mul_u32_u24 v10, 1280, v10
    v_lshl_add_u32 v10, v11, 4, v10
    s_add_u32 m0, s63, 0
    s_nop 0
    buffer_load_dwordx4 v10, s[32:35], s62 offen lds
    v_add_u32 v9, 64, v153
    v_mul_u32_u24 v10, 205, v9
    v_lshrrev_b32 v10, 11, v10
    v_mul_u32_u24 v11, 10, v10
    v_sub_u32 v11, v9, v11
    v_mul_u32_u24 v10, 1280, v10
    v_lshl_add_u32 v10, v11, 4, v10
    s_add_u32 m0, s63, 1024
    s_nop 0
    buffer_load_dwordx4 v10, s[32:35], s62 offen lds
    v_add_u32 v9, 128, v153
    v_mul_u32_u24 v10, 205, v9
    v_lshrrev_b32 v10, 11, v10
    v_mul_u32_u24 v11, 10, v10
    v_sub_u32 v11, v9, v11
    v_mul_u32_u24 v10, 1280, v10
    v_lshl_add_u32 v10, v11, 4, v10
    s_add_u32 m0, s63, 2048
    s_nop 0
    buffer_load_dwordx4 v10, s[32:35], s62 offen lds
    v_add_u32 v9, 192, v153
    v_mul_u32_u24 v10, 205, v9
    v_lshrrev_b32 v10, 11, v10
    v_mul_u32_u24 v11, 10, v10
    v_sub_u32 v11, v9, v11
    v_mul_u32_u24 v10, 1280, v10
    v_lshl_add_u32 v10, v11, 4, v10
    s_add_u32 m0, s63, 3072
    s_nop 0
    buffer_load_dwordx4 v10, s[32:35], s62 offen lds
    v_add_u32 v9, 256, v153
    v_mul_u32_u24 v10, 205, v9
    v_lshrrev_b32 v10, 11, v10
    v_mul_u32_u24 v11, 10, v10
    v_sub_u32 v11, v9, v11
    v_mul_u32_u24 v10, 1280, v10
    v_lshl_add_u32 v10, v11, 4, v10
    s_add_u32 m0, s63, 4096
    s_nop 0
    buffer_load_dwordx4 v10, s[32:35], s62 offen lds
    s_branch gated_mix__sliding_local_dilated__dense_activation_mish__prompt_kernel_ea_end2
gated_mix__sliding_local_dilated__dense_activation_mish__prompt_kernel_ea3_2:
    s_mov_b32 m0, 162880
    s_mov_b64 exec, 0xffffffff
    buffer_load_dwordx4 v152, s[32:35], s62 offen lds
    s_lshr_b32 s60, s3, 4
    s_lshl_b32 s60, s60, 8
    s_and_b32 s61, s3, 15
    s_lshl_b32 s61, s61, 2
    s_add_u32 s60, s60, s61
    s_add_u32 s60, s60, 15204352
    v_mov_b32 v9, 0
    s_mov_b64 exec, 1
    buffer_store_dword v9, v9, s[28:31], s60 offen sc1
    s_lshl_b32 s60, s3, 2
    s_add_u32 s60, s60, 15269888
    buffer_store_dword v9, v9, s[28:31], s60 offen sc1
    buffer_store_dword v9, v9, s[28:31], s64 offen
    buffer_store_dword v9, v9, s[28:31], s64 offen
    s_mov_b64 exec, -1
gated_mix__sliding_local_dilated__dense_activation_mish__prompt_kernel_ea_end2:
    s_waitcnt vmcnt(17)
    s_barrier
    s_call_b64 s[88:89], gated_mix__sliding_local_dilated__dense_activation_mish__prompt_kernel_dma0
    s_waitcnt vmcnt(17)
    s_barrier
    s_call_b64 s[88:89], gated_mix__sliding_local_dilated__dense_activation_mish__prompt_kernel_dma0
    s_waitcnt vmcnt(12)
    s_barrier
    s_cmp_eq_u32 s50, 3
    s_cbranch_scc0 gated_mix__sliding_local_dilated__dense_activation_mish__prompt_kernel_nordyhB
    s_mov_b32 s32, s98
    s_and_b32 s33, s99, 0xffff
    s_mov_b32 s34, 256
    s_mov_b32 s35, 0x20000
    v_mov_b32 v9, 1
    v_mov_b32 v10, 0
    s_mov_b64 exec, 1
    buffer_store_byte v9, v10, s[32:35], s3 offen sc1
    s_mov_b64 exec, -1
gated_mix__sliding_local_dilated__dense_activation_mish__prompt_kernel_nordyhB:
    s_call_b64 s[88:89], gated_mix__sliding_local_dilated__dense_activation_mish__prompt_kernel_dma0
    v_lshrrev_b32 v8, 2, v153
    v_mul_u32_u24 v8, 160, v8
    v_and_b32 v9, 3, v153
    v_lshl_add_u32 v8, v9, 3, v8
    v_add_u32 v8, s63, v8
    ds_read_b64_tr_b16 v[72:73], v8 offset:0
    ds_read_b64_tr_b16 v[74:75], v8 offset:2560
    ds_read_b64_tr_b16 v[76:77], v8 offset:32
    ds_read_b64_tr_b16 v[78:79], v8 offset:2592
    ds_read_b64_tr_b16 v[80:81], v8 offset:64
    ds_read_b64_tr_b16 v[82:83], v8 offset:2624
    ds_read_b64_tr_b16 v[84:85], v8 offset:96
    ds_read_b64_tr_b16 v[86:87], v8 offset:2656
    ds_read_b64_tr_b16 v[88:89], v8 offset:128
    ds_read_b64_tr_b16 v[90:91], v8 offset:2688
    s_waitcnt lgkmcnt(0)
    buffer_store_dwordx4 v[72:75], v152, s[28:31], s64 offen offset:0 sc1
    buffer_store_dwordx4 v[76:79], v152, s[28:31], s64 offen offset:1024 sc1
    buffer_store_dwordx4 v[80:83], v152, s[28:31], s64 offen offset:2048 sc1
    buffer_store_dwordx4 v[84:87], v152, s[28:31], s64 offen offset:3072 sc1
    buffer_store_dwordx4 v[88:91], v152, s[28:31], s65 offen sc1
    s_waitcnt vmcnt(17)
    s_barrier
    s_call_b64 s[88:89], gated_mix__sliding_local_dilated__dense_activation_mish__prompt_kernel_dma0
    s_mul_i32 s61, s49, 1280
    s_add_u32 s60, s61, 2560
    v_lshlrev_b32 v8, 2, v153
    buffer_load_dwordx4 v[16:19], v152, s[36:39], s61 offen offset:0
    buffer_load_dword v36, v8, s[36:39], s61 offen offset:1024
    buffer_load_dwordx4 v[20:23], v152, s[36:39], s61 offen offset:1280
    buffer_load_dword v37, v8, s[36:39], s61 offen offset:2304
    buffer_load_dwordx4 v[24:27], v152, s[36:39], s60 offen offset:0
    buffer_load_dword v38, v8, s[36:39], s60 offen offset:1024
    buffer_load_dwordx4 v[28:31], v152, s[36:39], s60 offen offset:1280
    buffer_load_dword v39, v8, s[36:39], s60 offen offset:2304
    buffer_load_dwordx4 v[32:35], v152, s[40:43], 0 offen
    buffer_load_dword v40, v8, s[40:43], 0 offen offset:1024
    s_waitcnt vmcnt(27)
    s_barrier
    s_call_b64 s[88:89], gated_mix__sliding_local_dilated__dense_activation_mish__prompt_kernel_dma0
    s_waitcnt vmcnt(22)
    s_barrier
    s_cmp_eq_u32 s50, 1
    s_cbranch_scc0 gated_mix__sliding_local_dilated__dense_activation_mish__prompt_kernel_nowfhB
    v_mov_b32 v9, 1
    v_mov_b32 v10, 0
    s_lshl_b32 s60, s3, 2
    s_add_u32 s60, s60, 15269888
    s_mov_b64 exec, 1
    buffer_store_dword v9, v10, s[28:31], s60 offen sc1
    s_mov_b64 exec, -1
gated_mix__sliding_local_dilated__dense_activation_mish__prompt_kernel_nowfhB:
    s_call_b64 s[88:89], gated_mix__sliding_local_dilated__dense_activation_mish__prompt_kernel_dma0
    s_cmp_eq_u32 s50, 0
    s_cbranch_scc0 gated_mix__sliding_local_dilated__dense_activation_mish__prompt_kernel_nodbghB
    s_mov_b32 s32, s98
    s_and_b32 s33, s99, 0xffff
    s_mov_b32 s34, 256
    s_mov_b32 s35, 0x20000
    s_and_b32 s60, s2, 7
    s_lshr_b32 s61, s2, 3
    s_lshl_b32 s56, s60, 2
    s_lshr_b32 s62, s61, 3
    s_add_u32 s56, s56, s62
    s_and_b32 s57, s61, 7
    s_lshr_b32 s58, s56, 1
    s_lshl_b32 s60, s58, 4
    s_lshl_b32 s61, s57, 5
    s_sub_u32 s61, s61, 16
    v_min_u32 v102, 11, v153
    v_lshlrev_b32 v100, 2, v102
    v_cmp_gt_u32 vcc, 4, v102
    v_mov_b32 v103, s61
    v_mov_b32 v104, s60
    v_cndmask_b32 v103, v103, v104, vcc
    v_add_u32 v100, v100, v103
    buffer_load_dword v101, v100, s[32:35], 0 offen sc1
gated_mix__sliding_local_dilated__dense_activation_mish__prompt_kernel_nodbghB:
    s_waitcnt vmcnt(12)
    s_barrier
    s_call_b64 s[88:89], gated_mix__sliding_local_dilated__dense_activation_mish__prompt_kernel_dma0
    s_mov_b32 s68, 0xffff0000
    v_lshlrev_b32 v48, 16, v16
    v_and_b32 v49, s68, v16
    v_lshlrev_b32 v50, 16, v32
    v_and_b32 v51, s68, v32
    v_pk_mul_f32 v[48:49], v[48:49], v[50:51]
    v_cvt_pk_bf16_f32 v48, v48, v49
    v_and_b32 v49, s68, v48
    v_lshlrev_b32 v48, 16, v48
    v_lshlrev_b32 v52, 16, v17
    v_and_b32 v53, s68, v17
    v_lshlrev_b32 v54, 16, v33
    v_and_b32 v55, s68, v33
    v_pk_mul_f32 v[52:53], v[52:53], v[54:55]
    v_cvt_pk_bf16_f32 v52, v52, v53
    v_and_b32 v53, s68, v52
    v_lshlrev_b32 v52, 16, v52
    v_lshlrev_b32 v56, 16, v18
    v_and_b32 v57, s68, v18
    v_lshlrev_b32 v58, 16, v34
    v_and_b32 v59, s68, v34
    v_pk_mul_f32 v[56:57], v[56:57], v[58:59]
    v_cvt_pk_bf16_f32 v56, v56, v57
    v_and_b32 v57, s68, v56
    v_lshlrev_b32 v56, 16, v56
    v_lshlrev_b32 v60, 16, v19
    v_and_b32 v61, s68, v19
    v_lshlrev_b32 v62, 16, v35
    v_and_b32 v63, s68, v35
    v_pk_mul_f32 v[60:61], v[60:61], v[62:63]
    v_cvt_pk_bf16_f32 v60, v60, v61
    v_and_b32 v61, s68, v60
    v_lshlrev_b32 v60, 16, v60
    v_lshlrev_b32 v64, 16, v36
    v_and_b32 v65, s68, v36
    v_lshlrev_b32 v66, 16, v40
    v_and_b32 v67, s68, v40
    v_pk_mul_f32 v[64:65], v[64:65], v[66:67]
    v_cvt_pk_bf16_f32 v64, v64, v65
    v_and_b32 v65, s68, v64
    v_lshlrev_b32 v64, 16, v64
    v_pk_add_f32 v[48:49], v[48:49], v[52:53]
    v_pk_add_f32 v[56:57], v[56:57], v[60:61]
    v_pk_add_f32 v[48:49], v[48:49], v[64:65]
    v_pk_add_f32 v[48:49], v[48:49], v[56:57]
    v_add_f32 v44, v48, v49
    v_lshlrev_b32 v48, 16, v20
    v_and_b32 v49, s68, v20
    v_lshlrev_b32 v50, 16, v32
    v_and_b32 v51, s68, v32
    v_pk_mul_f32 v[48:49], v[48:49], v[50:51]
    v_cvt_pk_bf16_f32 v48, v48, v49
    v_and_b32 v49, s68, v48
    v_lshlrev_b32 v48, 16, v48
    v_lshlrev_b32 v52, 16, v21
    v_and_b32 v53, s68, v21
    v_lshlrev_b32 v54, 16, v33
    v_and_b32 v55, s68, v33
    v_pk_mul_f32 v[52:53], v[52:53], v[54:55]
    v_cvt_pk_bf16_f32 v52, v52, v53
    v_and_b32 v53, s68, v52
    v_lshlrev_b32 v52, 16, v52
    v_lshlrev_b32 v56, 16, v22
    v_and_b32 v57, s68, v22
    v_lshlrev_b32 v58, 16, v34
    v_and_b32 v59, s68, v34
    v_pk_mul_f32 v[56:57], v[56:57], v[58:59]
    v_cvt_pk_bf16_f32 v56, v56, v57
    v_and_b32 v57, s68, v56
    v_lshlrev_b32 v56, 16, v56
    v_lshlrev_b32 v60, 16, v23
    v_and_b32 v61, s68, v23
    v_lshlrev_b32 v62, 16, v35
    v_and_b32 v63, s68, v35
    v_pk_mul_f32 v[60:61], v[60:61], v[62:63]
    v_cvt_pk_bf16_f32 v60, v60, v61
    v_and_b32 v61, s68, v60
    v_lshlrev_b32 v60, 16, v60
    v_lshlrev_b32 v64, 16, v37
    v_and_b32 v65, s68, v37
    v_lshlrev_b32 v66, 16, v40
    v_and_b32 v67, s68, v40
    v_pk_mul_f32 v[64:65], v[64:65], v[66:67]
    v_cvt_pk_bf16_f32 v64, v64, v65
    v_and_b32 v65, s68, v64
    v_lshlrev_b32 v64, 16, v64
    v_pk_add_f32 v[48:49], v[48:49], v[52:53]
    v_pk_add_f32 v[56:57], v[56:57], v[60:61]
    v_pk_add_f32 v[48:49], v[48:49], v[64:65]
    v_pk_add_f32 v[48:49], v[48:49], v[56:57]
    v_add_f32 v45, v48, v49
    v_lshlrev_b32 v48, 16, v24
    v_and_b32 v49, s68, v24
    v_lshlrev_b32 v50, 16, v32
    v_and_b32 v51, s68, v32
    v_pk_mul_f32 v[48:49], v[48:49], v[50:51]
    v_cvt_pk_bf16_f32 v48, v48, v49
    v_and_b32 v49, s68, v48
    v_lshlrev_b32 v48, 16, v48
    v_lshlrev_b32 v52, 16, v25
    v_and_b32 v53, s68, v25
    v_lshlrev_b32 v54, 16, v33
    v_and_b32 v55, s68, v33
    v_pk_mul_f32 v[52:53], v[52:53], v[54:55]
    v_cvt_pk_bf16_f32 v52, v52, v53
    v_and_b32 v53, s68, v52
    v_lshlrev_b32 v52, 16, v52
    v_lshlrev_b32 v56, 16, v26
    v_and_b32 v57, s68, v26
    v_lshlrev_b32 v58, 16, v34
    v_and_b32 v59, s68, v34
    v_pk_mul_f32 v[56:57], v[56:57], v[58:59]
    v_cvt_pk_bf16_f32 v56, v56, v57
    v_and_b32 v57, s68, v56
    v_lshlrev_b32 v56, 16, v56
    v_lshlrev_b32 v60, 16, v27
    v_and_b32 v61, s68, v27
    v_lshlrev_b32 v62, 16, v35
    v_and_b32 v63, s68, v35
    v_pk_mul_f32 v[60:61], v[60:61], v[62:63]
    v_cvt_pk_bf16_f32 v60, v60, v61
    v_and_b32 v61, s68, v60
    v_lshlrev_b32 v60, 16, v60
    v_lshlrev_b32 v64, 16, v38
    v_and_b32 v65, s68, v38
    v_lshlrev_b32 v66, 16, v40
    v_and_b32 v67, s68, v40
    v_pk_mul_f32 v[64:65], v[64:65], v[66:67]
    v_cvt_pk_bf16_f32 v64, v64, v65
    v_and_b32 v65, s68, v64
    v_lshlrev_b32 v64, 16, v64
    v_pk_add_f32 v[48:49], v[48:49], v[52:53]
    v_pk_add_f32 v[56:57], v[56:57], v[60:61]
    v_pk_add_f32 v[48:49], v[48:49], v[64:65]
    v_pk_add_f32 v[48:49], v[48:49], v[56:57]
    v_add_f32 v46, v48, v49
    v_lshlrev_b32 v48, 16, v28
    v_and_b32 v49, s68, v28
    v_lshlrev_b32 v50, 16, v32
    v_and_b32 v51, s68, v32
    v_pk_mul_f32 v[48:49], v[48:49], v[50:51]
    v_cvt_pk_bf16_f32 v48, v48, v49
    v_and_b32 v49, s68, v48
    v_lshlrev_b32 v48, 16, v48
    v_lshlrev_b32 v52, 16, v29
    v_and_b32 v53, s68, v29
    v_lshlrev_b32 v54, 16, v33
    v_and_b32 v55, s68, v33
    v_pk_mul_f32 v[52:53], v[52:53], v[54:55]
    v_cvt_pk_bf16_f32 v52, v52, v53
    v_and_b32 v53, s68, v52
    v_lshlrev_b32 v52, 16, v52
    v_lshlrev_b32 v56, 16, v30
    v_and_b32 v57, s68, v30
    v_lshlrev_b32 v58, 16, v34
    v_and_b32 v59, s68, v34
    v_pk_mul_f32 v[56:57], v[56:57], v[58:59]
    v_cvt_pk_bf16_f32 v56, v56, v57
    v_and_b32 v57, s68, v56
    v_lshlrev_b32 v56, 16, v56
    v_lshlrev_b32 v60, 16, v31
    v_and_b32 v61, s68, v31
    v_lshlrev_b32 v62, 16, v35
    v_and_b32 v63, s68, v35
    v_pk_mul_f32 v[60:61], v[60:61], v[62:63]
    v_cvt_pk_bf16_f32 v60, v60, v61
    v_and_b32 v61, s68, v60
    v_lshlrev_b32 v60, 16, v60
    v_lshlrev_b32 v64, 16, v39
    v_and_b32 v65, s68, v39
    v_lshlrev_b32 v66, 16, v40
    v_and_b32 v67, s68, v40
    v_pk_mul_f32 v[64:65], v[64:65], v[66:67]
    v_cvt_pk_bf16_f32 v64, v64, v65
    v_and_b32 v65, s68, v64
    v_lshlrev_b32 v64, 16, v64
    v_pk_add_f32 v[48:49], v[48:49], v[52:53]
    v_pk_add_f32 v[56:57], v[56:57], v[60:61]
    v_pk_add_f32 v[48:49], v[48:49], v[64:65]
    v_pk_add_f32 v[48:49], v[48:49], v[56:57]
    v_add_f32 v47, v48, v49
    v_add_f32_dpp v44, v44, v44 row_ror:1 row_mask:0xf bank_mask:0xf
    v_add_f32_dpp v45, v45, v45 row_ror:1 row_mask:0xf bank_mask:0xf
    v_add_f32_dpp v46, v46, v46 row_ror:1 row_mask:0xf bank_mask:0xf
    v_add_f32_dpp v47, v47, v47 row_ror:1 row_mask:0xf bank_mask:0xf
    v_add_f32_dpp v44, v44, v44 row_ror:2 row_mask:0xf bank_mask:0xf
    v_add_f32_dpp v45, v45, v45 row_ror:2 row_mask:0xf bank_mask:0xf
    v_add_f32_dpp v46, v46, v46 row_ror:2 row_mask:0xf bank_mask:0xf
    v_add_f32_dpp v47, v47, v47 row_ror:2 row_mask:0xf bank_mask:0xf
    v_add_f32_dpp v44, v44, v44 row_ror:4 row_mask:0xf bank_mask:0xf
    v_add_f32_dpp v45, v45, v45 row_ror:4 row_mask:0xf bank_mask:0xf
    v_add_f32_dpp v46, v46, v46 row_ror:4 row_mask:0xf bank_mask:0xf
    v_add_f32_dpp v47, v47, v47 row_ror:4 row_mask:0xf bank_mask:0xf
    v_add_f32_dpp v44, v44, v44 row_ror:8 row_mask:0xf bank_mask:0xf
    v_add_f32_dpp v45, v45, v45 row_ror:8 row_mask:0xf bank_mask:0xf
    v_add_f32_dpp v46, v46, v46 row_ror:8 row_mask:0xf bank_mask:0xf
    v_add_f32_dpp v47, v47, v47 row_ror:8 row_mask:0xf bank_mask:0xf
    v_mov_b32 v48, v44
    v_mov_b32 v49, v45
    v_mov_b32 v50, v46
    v_mov_b32 v51, v47
    v_permlane16_swap_b32 v48, v44
    v_permlane16_swap_b32 v49, v45
    v_permlane16_swap_b32 v50, v46
    v_permlane16_swap_b32 v51, v47
    v_add_f32 v44, v44, v48
    v_add_f32 v45, v45, v49
    v_add_f32 v46, v46, v50
    v_add_f32 v47, v47, v51
    v_mov_b32 v48, v44
    v_mov_b32 v49, v45
    v_mov_b32 v50, v46
    v_mov_b32 v51, v47
    v_permlane32_swap_b32 v48, v44
    v_permlane32_swap_b32 v49, v45
    v_permlane32_swap_b32 v50, v46
    v_permlane32_swap_b32 v51, v47
    v_add_f32 v44, v44, v48
    v_add_f32 v45, v45, v49
    v_add_f32 v46, v46, v50
    v_add_f32 v47, v47, v51
    v_cvt_pk_bf16_f32 v44, v44, v44
    v_cvt_pk_bf16_f32 v45, v45, v45
    v_cvt_pk_bf16_f32 v46, v46, v46
    v_cvt_pk_bf16_f32 v47, v47, v47
    v_lshlrev_b32 v44, 16, v44
    v_lshlrev_b32 v45, 16, v45
    v_lshlrev_b32 v46, 16, v46
    v_lshlrev_b32 v47, 16, v47
    v_mul_f32 v44, 0xbfb8aa3b, v44
    v_mul_f32 v45, 0xbfb8aa3b, v45
    v_mul_f32 v46, 0xbfb8aa3b, v46
    v_mul_f32 v47, 0xbfb8aa3b, v47
    v_exp_f32 v44, v44
    v_exp_f32 v45, v45
    v_exp_f32 v46, v46
    v_exp_f32 v47, v47
    v_add_f32 v44, 1.0, v44
    v_add_f32 v45, 1.0, v45
    v_add_f32 v46, 1.0, v46
    v_add_f32 v47, 1.0, v47
    v_rcp_f32 v44, v44
    v_rcp_f32 v45, v45
    v_rcp_f32 v46, v46
    v_rcp_f32 v47, v47
    v_cvt_pk_bf16_f32 v44, v44, v44
    v_cvt_pk_bf16_f32 v45, v45, v45
    v_cvt_pk_bf16_f32 v46, v46, v46
    v_cvt_pk_bf16_f32 v47, v47, v47
    v_lshlrev_b32 v44, 16, v44
    v_lshlrev_b32 v45, 16, v45
    v_lshlrev_b32 v46, 16, v46
    v_lshlrev_b32 v47, 16, v47
    s_lshl_b32 s60, s50, 4
    s_add_u32 s60, s60, 162816
    v_mov_b32 v8, s60
    s_mov_b64 exec, 1
    ds_write_b128 v8, v[44:47]
    s_mov_b64 exec, -1
    s_waitcnt lgkmcnt(0)
    s_waitcnt vmcnt(12)
    s_barrier
    s_cmp_eq_u32 s50, 0
    s_cbranch_scc1 gated_mix__sliding_local_dilated__dense_activation_mish__prompt_kernel_htail
    s_waitcnt vmcnt(0)
    s_barrier
    s_endpgm
gated_mix__sliding_local_dilated__dense_activation_mish__prompt_kernel_htail:
    s_setprio 0
    s_waitcnt vmcnt(0)
    s_barrier
    v_and_b32 v13, 31, v153
    v_lshlrev_b32 v13, 2, v13
    s_lshl_b32 s23, s57, 7
    s_add_u32 s23, s23, 15269888
    buffer_load_dword v14, v13, s[28:31], s23 offen sc1
    s_mul_i32 s72, s57, 378880
    s_add_u32 s72, s72, 10485760
    s_and_b32 s60, s57, 3
    s_lshl_b32 s60, s60, 1
    s_and_b32 s61, s56, 7
    s_add_u32 s60, s60, s61
    s_sub_u32 s61, s60, 9
    s_cmp_ge_u32 s60, 9
    s_cselect_b32 s59, s61, s60
    s_mul_i32 s59, s59, 0
    s_mov_b32 s26, 0x01010101
    s_barrier
    s_cmp_eq_u32 s51, 0
    s_cbranch_scc0 gated_mix__sliding_local_dilated__dense_activation_mish__prompt_kernel_hnoattn
    s_barrier
gated_mix__sliding_local_dilated__dense_activation_mish__prompt_kernel_hnoattn:
    s_mov_b32 s27, 0
gated_mix__sliding_local_dilated__dense_activation_mish__prompt_kernel_hwf:
    s_waitcnt vmcnt(0)
    v_and_b32 v101, s26, v101
    v_cmp_ne_u32 vcc, s26, v101
    s_cbranch_vccnz gated_mix__sliding_local_dilated__dense_activation_mish__prompt_kernel_hretry
    v_cmp_ne_u32 vcc, 1, v14
    s_cbranch_vccz gated_mix__sliding_local_dilated__dense_activation_mish__prompt_kernel_hwfok
gated_mix__sliding_local_dilated__dense_activation_mish__prompt_kernel_hretry:
    s_add_u32 s27, s27, 1
    s_cmp_gt_u32 s27, 0x8000
    s_cbranch_scc1 gated_mix__sliding_local_dilated__dense_activation_mish__prompt_kernel_hwfok
    s_sleep 8
    buffer_load_dword v101, v100, s[32:35], 0 offen sc1
    s_waitcnt vmcnt(0)
    buffer_load_dword v14, v13, s[28:31], s23 offen sc1
    s_branch gated_mix__sliding_local_dilated__dense_activation_mish__prompt_kernel_hwf
gated_mix__sliding_local_dilated__dense_activation_mish__prompt_kernel_hwfok:
    s_mov_b32 s73, 0
    s_mov_b32 s74, s72
    s_mov_b32 s75, 81920
gated_mix__sliding_local_dilated__dense_activation_mish__prompt_kernel_hwa:
    s_cmp_lt_u32 s73, 2
    s_cselect_b32 s76, 10, 9
    s_add_u32 s77, s59, 0
    s_sub_u32 s78, s77, s76
    s_cmp_ge_u32 s77, s76
    s_cselect_b32 s77, s78, s77
    s_mul_i32 s77, s77, 5120
    s_add_u32 s69, s74, s77
    s_add_u32 m0, s75, 0
    s_nop 0
    buffer_load_dwordx4 v152, s[28:31], s69 offen offset:0 lds
    buffer_load_dwordx4 v152, s[28:31], s69 offen offset:1024 lds
    buffer_load_dwordx4 v152, s[28:31], s69 offen offset:2048 lds
    buffer_load_dwordx4 v152, s[28:31], s69 offen offset:3072 lds
    s_add_u32 m0, s75, 4096
    s_add_u32 s69, s69, 4096
    buffer_load_dwordx4 v152, s[28:31], s69 offen lds
    s_add_u32 s77, s59, 1
    s_sub_u32 s78, s77, s76
    s_cmp_ge_u32 s77, s76
    s_cselect_b32 s77, s78, s77
    s_mul_i32 s77, s77, 5120
    s_add_u32 s69, s74, s77
    s_add_u32 m0, s75, 40960
    s_nop 0
    buffer_load_dwordx4 v152, s[28:31], s69 offen offset:0 lds
    buffer_load_dwordx4 v152, s[28:31], s69 offen offset:1024 lds
    buffer_load_dwordx4 v152, s[28:31], s69 offen offset:2048 lds
    buffer_load_dwordx4 v152, s[28:31], s69 offen offset:3072 lds
    s_add_u32 m0, s75, 45056
    s_add_u32 s69, s69, 4096
    buffer_load_dwordx4 v152, s[28:31], s69 offen lds
    s_add_u32 s75, s75, 5120
    s_mul_i32 s77, s76, 5120
    s_add_u32 s74, s74, s77
    s_add_u32 s73, s73, 1
    s_cmp_lt_u32 s73, 8
    s_cbranch_scc1 gated_mix__sliding_local_dilated__dense_activation_mish__prompt_kernel_hwa
    v_mov_b32 v11, 1
    v_mov_b32 v10, 0
    s_lshr_b32 s60, s3, 4
    s_lshl_b32 s60, s60, 8
    s_and_b32 s61, s3, 15
    s_lshl_b32 s61, s61, 2
    s_add_u32 s60, s60, s61
    s_add_u32 s60, s60, 15204352
    s_waitcnt vmcnt(0)
    s_setprio 3
    s_barrier
    s_mov_b64 exec, 1
    buffer_store_dword v11, v10, s[28:31], s60 offen sc1
    s_endpgm
gated_mix__sliding_local_dilated__dense_activation_mish__prompt_kernel_compute:
    s_sub_u32 s50, s50, 4
    s_and_b32 s57, s50, 1
    s_lshr_b32 s58, s50, 1
    s_lshl_b32 s60, s58, 2
    s_cmp_eq_u32 s58, 3
    s_cselect_b32 s61, 10, s60
    s_cmp_eq_u32 s56, 1
    s_cselect_b32 s60, s61, s60
    s_and_b32 s61, s58, 1
    s_lshl_b32 s61, s61, 3
    s_lshr_b32 s62, s58, 1
    s_lshl_b32 s62, s62, 2
    s_add_u32 s61, s61, s62
    s_cmp_eq_u32 s51, 0
    s_cselect_b32 s59, s61, s60
    v_and_b32 v72, 15, v153
    v_lshrrev_b32 v73, 4, v153
    v_lshrrev_b32 v74, 1, v72
    v_xor_b32 v75, v73, v74
    v_lshlrev_b32 v75, 4, v75
    v_lshl_add_u32 v150, v72, 7, v75
    v_xor_b32 v151, 64, v150
    s_lshl_b32 s60, s57, 13
    s_add_u32 s60, s60, 2048
    v_add_u32 v148, s60, v150
    v_add_u32 v149, s60, v151
    v_lshrrev_b32 v74, 1, v73
    v_and_b32 v75, 1, v73
    v_lshrrev_b32 v76, 3, v72
    v_lshl_add_u32 v76, v75, 1, v76
    v_lshl_add_u32 v76, v74, 3, v76
    v_mul_u32_u24 v76, 960, v76
    v_and_b32 v77, 3, v72
    v_lshl_add_u32 v76, v77, 3, v76
    v_add_u32 v76, 18432, v76
    v_bfe_u32 v77, v72, 2, 1
    v_cmp_eq_u32 vcc, 1, v77
    s_cmp_eq_u32 s51, 0
    s_cselect_b32 s62, 12, 14
    s_and_b32 s63, s53, 1
    s_cmp_eq_u32 s51, 0
    s_cselect_b32 s63, s63, 0
    s_add_u32 s69, s59, 0
    s_mul_i32 s60, s69, 13
    s_lshr_b32 s60, s60, 6
    s_mul_i32 s61, s60, 5
    s_sub_u32 s61, s69, s61
    s_sub_u32 s61, s61, s63
    s_lshl_b32 s78, s60, 2
    s_add_u32 s78, s78, s61
    s_cmp_eq_u32 s51, 0
    s_cselect_b32 s78, s78, s69
    s_cselect_b32 s79, s61, 0
    s_xor_b32 s77, s78, 1
    s_add_u32 s77, s77, s62
    s_add_u32 s76, s60, 24
    s_add_u32 s69, s60, 27
    s_cmp_gt_u32 s79, 3
    s_cselect_b32 s78, s76, s78
    s_cselect_b32 s77, s69, s77
    s_lshl_b32 s78, s78, 5
    s_lshl_b32 s77, s77, 5
    v_mov_b32 v78, s78
    v_mov_b32 v79, s77
    v_cndmask_b32 v78, v78, v79, vcc
    v_add_u32 v144, v78, v76
    s_add_u32 s69, s59, 1
    s_mul_i32 s60, s69, 13
    s_lshr_b32 s60, s60, 6
    s_mul_i32 s61, s60, 5
    s_sub_u32 s61, s69, s61
    s_sub_u32 s61, s61, s63
    s_lshl_b32 s78, s60, 2
    s_add_u32 s78, s78, s61
    s_cmp_eq_u32 s51, 0
    s_cselect_b32 s78, s78, s69
    s_cselect_b32 s79, s61, 0
    s_xor_b32 s77, s78, 1
    s_add_u32 s77, s77, s62
    s_add_u32 s76, s60, 24
    s_add_u32 s69, s60, 27
    s_cmp_gt_u32 s79, 3
    s_cselect_b32 s78, s76, s78
    s_cselect_b32 s77, s69, s77
    s_lshl_b32 s78, s78, 5
    s_lshl_b32 s77, s77, 5
    v_mov_b32 v78, s78
    v_mov_b32 v79, s77
    v_cndmask_b32 v78, v78, v79, vcc
    v_add_u32 v145, v78, v76
    s_add_u32 s69, s59, 2
    s_mul_i32 s60, s69, 13
    s_lshr_b32 s60, s60, 6
    s_mul_i32 s61, s60, 5
    s_sub_u32 s61, s69, s61
    s_sub_u32 s61, s61, s63
    s_lshl_b32 s78, s60, 2
    s_add_u32 s78, s78, s61
    s_cmp_eq_u32 s51, 0
    s_cselect_b32 s78, s78, s69
    s_cselect_b32 s79, s61, 0
    s_xor_b32 s77, s78, 1
    s_add_u32 s77, s77, s62
    s_add_u32 s76, s60, 24
    s_add_u32 s69, s60, 27
    s_cmp_gt_u32 s79, 3
    s_cselect_b32 s78, s76, s78
    s_cselect_b32 s77, s69, s77
    s_lshl_b32 s78, s78, 5
    s_lshl_b32 s77, s77, 5
    v_mov_b32 v78, s78
    v_mov_b32 v79, s77
    v_cndmask_b32 v78, v78, v79, vcc
    v_add_u32 v146, v78, v76
    s_add_u32 s69, s59, 3
    s_mul_i32 s60, s69, 13
    s_lshr_b32 s60, s60, 6
    s_mul_i32 s61, s60, 5
    s_sub_u32 s61, s69, s61
    s_sub_u32 s61, s61, s63
    s_lshl_b32 s78, s60, 2
    s_add_u32 s78, s78, s61
    s_cmp_eq_u32 s51, 0
    s_cselect_b32 s78, s78, s69
    s_cselect_b32 s79, s61, 0
    s_xor_b32 s77, s78, 1
    s_add_u32 s77, s77, s62
    s_add_u32 s76, s60, 24
    s_add_u32 s69, s60, 27
    s_cmp_gt_u32 s79, 3
    s_cselect_b32 s78, s76, s78
    s_cselect_b32 s77, s69, s77
    s_lshl_b32 s78, s78, 5
    s_lshl_b32 s77, s77, 5
    v_mov_b32 v78, s78
    v_mov_b32 v79, s77
    v_cndmask_b32 v78, v78, v79, vcc
    v_add_u32 v147, v78, v76
    v_mov_b32 v0, 0
    v_mov_b32 v1, 0
    v_mov_b32 v2, 0
    v_mov_b32 v3, 0
    v_mov_b32 v4, 0
    v_mov_b32 v5, 0
    v_mov_b32 v6, 0
    v_mov_b32 v7, 0
    v_mov_b32 v8, 0
    v_mov_b32 v9, 0
    v_mov_b32 v10, 0
    v_mov_b32 v11, 0
    v_mov_b32 v12, 0
    v_mov_b32 v13, 0
    v_mov_b32 v14, 0
    v_mov_b32 v15, 0
    v_mov_b32 v16, 0
    v_mov_b32 v17, 0
    v_mov_b32 v18, 0
    v_mov_b32 v19, 0
    v_mov_b32 v20, 0
    v_mov_b32 v21, 0
    v_mov_b32 v22, 0
    v_mov_b32 v23, 0
    v_mov_b32 v24, 0
    v_mov_b32 v25, 0
    v_mov_b32 v26, 0
    v_mov_b32 v27, 0
    v_mov_b32 v28, 0
    v_mov_b32 v29, 0
    v_mov_b32 v30, 0
    v_mov_b32 v31, 0
    v_mov_b32 v32, 0
    v_mov_b32 v33, 0
    v_mov_b32 v34, 0
    v_mov_b32 v35, 0
    v_mov_b32 v36, 0
    v_mov_b32 v37, 0
    v_mov_b32 v38, 0
    v_mov_b32 v39, 0
    v_mov_b32 v40, 0
    v_mov_b32 v41, 0
    v_mov_b32 v42, 0
    v_mov_b32 v43, 0
    v_mov_b32 v44, 0
    v_mov_b32 v45, 0
    v_mov_b32 v46, 0
    v_mov_b32 v47, 0
    v_mov_b32 v48, 0
    v_mov_b32 v49, 0
    v_mov_b32 v50, 0
    v_mov_b32 v51, 0
    v_mov_b32 v52, 0
    v_mov_b32 v53, 0
    v_mov_b32 v54, 0
    v_mov_b32 v55, 0
    v_mov_b32 v56, 0
    v_mov_b32 v57, 0
    v_mov_b32 v58, 0
    v_mov_b32 v59, 0
    v_mov_b32 v60, 0
    v_mov_b32 v61, 0
    v_mov_b32 v62, 0
    v_mov_b32 v63, 0
    v_mov_b32 v64, 0
    v_mov_b32 v65, 0
    v_mov_b32 v66, 0
    v_mov_b32 v67, 0
    v_mov_b32 v68, 0
    v_mov_b32 v69, 0
    v_mov_b32 v70, 0
    v_mov_b32 v71, 0
    s_waitcnt lgkmcnt(0)
    s_mov_b32 s28, s10
    s_and_b32 s29, s11, 0xffff
    s_mov_b32 s30, 16777216
    s_mov_b32 s31, 0x20000
    s_mov_b32 s44, s14
    s_and_b32 s45, s15, 0xffff
    s_mov_b32 s46, 3456
    s_mov_b32 s47, 0x20000
    s_mov_b32 s32, s98
    s_and_b32 s33, s99, 0xffff
    s_mov_b32 s34, 256
    s_mov_b32 s35, 0x20000
    s_mov_b32 s36, s96
    s_and_b32 s37, s97, 0xffff
    s_mov_b32 s38, 2621440
    s_mov_b32 s39, 0x20000
    s_and_b32 s60, s2, 7
    s_lshr_b32 s61, s2, 3
    s_lshl_b32 s20, s60, 2
    s_lshr_b32 s62, s61, 3
    s_add_u32 s20, s20, s62
    s_and_b32 s21, s61, 7
    s_mul_i32 s60, s50, 9
    s_add_u32 s60, s60, 2
    s_mul_i32 s61, s50, 10
    s_cmp_lt_u32 s50, 2
    s_cselect_b32 s60, s61, s60
    s_mul_i32 s22, s20, 74
    s_add_u32 s22, s22, s60
    s_lshl_b32 s22, s22, 12
    s_mul_i32 s23, s21, 74
    s_add_u32 s23, s23, s60
    s_mul_i32 s23, s23, 5120
    s_add_u32 s23, s23, 10485760
    s_and_b32 s60, s21, 3
    s_lshl_b32 s60, s60, 1
    s_and_b32 s61, s20, 7
    s_add_u32 s60, s60, s61
    s_sub_u32 s61, s60, 9
    s_cmp_ge_u32 s60, 9
    s_cselect_b32 s26, s61, s60
    s_mul_i32 s26, s26, 0
    s_cmp_lt_u32 s50, 2
    s_cselect_b32 s48, 10, 9
    s_add_u32 s27, s26, 2
    s_sub_u32 s60, s27, s48
    s_cmp_ge_u32 s27, s48
    s_cselect_b32 s27, s60, s27
    s_lshl_b32 s60, s26, 12
    s_add_u32 s22, s22, s60
    s_mul_i32 s60, s27, 5120
    s_add_u32 s23, s23, s60
    s_mul_i32 s24, s50, 5120
    s_cmp_eq_u32 s50, 0
    s_cselect_b32 s25, 7, 99
    s_lshr_b32 s60, s3, 5
    s_and_b32 s61, s3, 31
    s_lshl_b32 s62, s50, 5
    s_add_u32 s61, s61, s62
    s_mul_i32 s60, s60, 74
    s_add_u32 s60, s60, s61
    s_mul_i32 s60, s60, 5120
    s_add_u32 s40, s60, 10485760
    s_cmp_lt_u32 s61, 74
    s_cselect_b32 s40, s40, 0x80000000
    s_add_u32 s41, s40, 4096
    s_mul_i32 s42, s50, 5120
    s_add_u32 s42, s42, 147456
    s_lshl_b32 s60, s53, 4
    s_add_u32 s60, s60, s52
    s_lshl_b32 s60, s60, 2
    s_add_u32 s43, s60, 14680064
    s_cmp_eq_u32 s51, 1
    s_cselect_b32 s43, s43, 0x80000000
    s_mov_b32 s76, 0
    s_mov_b32 s77, 0
    s_mov_b32 s49, 49152
    s_cmp_eq_u32 s51, 0
    s_cbranch_scc1 gated_mix__sliding_local_dilated__dense_activation_mish__prompt_kernel_dispA
    s_add_u32 s60, s58, s56
    s_cmp_lt_u32 s60, 3
    s_cbranch_scc1 gated_mix__sliding_local_dilated__dense_activation_mish__prompt_kernel_c4
    s_branch gated_mix__sliding_local_dilated__dense_activation_mish__prompt_kernel_c3
gated_mix__sliding_local_dilated__dense_activation_mish__prompt_kernel_dispA:
    s_cmp_eq_u32 s50, 2
    s_cbranch_scc1 gated_mix__sliding_local_dilated__dense_activation_mish__prompt_kernel_c4a
    s_cmp_eq_u32 s50, 3
    s_cbranch_scc1 gated_mix__sliding_local_dilated__dense_activation_mish__prompt_kernel_c4b
    s_cmp_eq_u32 s50, 4
    s_cbranch_scc1 gated_mix__sliding_local_dilated__dense_activation_mish__prompt_kernel_c4b
    s_cmp_eq_u32 s50, 5
    s_cbranch_scc1 gated_mix__sliding_local_dilated__dense_activation_mish__prompt_kernel_c4c
    s_cmp_eq_u32 s50, 6
    s_cbranch_scc1 gated_mix__sliding_local_dilated__dense_activation_mish__prompt_kernel_c3a
    s_cmp_eq_u32 s50, 7
    s_cbranch_scc1 gated_mix__sliding_local_dilated__dense_activation_mish__prompt_kernel_c3b
    s_branch gated_mix__sliding_local_dilated__dense_activation_mish__prompt_kernel_c4
gated_mix__sliding_local_dilated__dense_activation_mish__prompt_kernel_auxg:
    v_lshrrev_b32 v108, 4, v153
    v_lshlrev_b32 v108, 3, v108
    s_lshl_b32 s60, s59, 5
    s_add_u32 s60, s60, 162880
    v_add_u32 v108, s60, v108
    ds_read_b64 v[154:155], v108
    ds_read_b64 v[156:157], v108 offset:32
    ds_read_b64 v[158:159], v108 offset:64
    ds_read_b64 v[160:161], v108 offset:96
    s_cmp_eq_u32 s50, 3
    s_cbranch_scc0 gated_mix__sliding_local_dilated__dense_activation_mish__prompt_kernel_auxret
    v_lshlrev_b32 v108, 2, v153
    v_add_u32 v109, 162816, v108
    s_mov_b64 exec, 0xffff
    ds_read_b32 v110, v109
    s_waitcnt lgkmcnt(0)
    buffer_store_dword v110, v108, s[28:31], s43 offen sc1
    s_mov_b64 exec, -1
gated_mix__sliding_local_dilated__dense_activation_mish__prompt_kernel_auxret:
    s_setpc_b64 s[88:89]
gated_mix__sliding_local_dilated__dense_activation_mish__prompt_kernel_c4:
    s_barrier
    ds_read_b64_tr_b16 v[92:93], v144 offset:0
    ds_read_b64_tr_b16 v[94:95], v144 offset:3840
    ds_read_b128 v[72:75], v148 offset:0
    ds_read_b128 v[76:79], v148 offset:2048
    ds_read_b128 v[80:83], v148 offset:4096
    ds_read_b128 v[84:87], v148 offset:6144
    ds_read_b64_tr_b16 v[96:97], v145 offset:0
    ds_read_b64_tr_b16 v[98:99], v145 offset:3840
    ds_read_b64_tr_b16 v[100:101], v146 offset:0
    ds_read_b64_tr_b16 v[102:103], v146 offset:3840
    ds_read_b64_tr_b16 v[104:105], v147 offset:0
    ds_read_b64_tr_b16 v[106:107], v147 offset:3840
gated_mix__sliding_local_dilated__dense_activation_mish__prompt_kernel_c4_loop:
    s_waitcnt lgkmcnt(0)
    v_mfma_f32_16x16x32_bf16 v[0:3], v[92:95], v[72:75], v[0:3]
    ds_read_b64_tr_b16 v[128:129], v144 offset:15360
    v_mfma_f32_16x16x32_bf16 v[16:19], v[92:95], v[76:79], v[16:19]
    ds_read_b64_tr_b16 v[130:131], v144 offset:19200
    v_mfma_f32_16x16x32_bf16 v[32:35], v[92:95], v[80:83], v[32:35]
    ds_read_b128 v[108:111], v149 offset:0
    v_mfma_f32_16x16x32_bf16 v[48:51], v[92:95], v[84:87], v[48:51]
    ds_read_b128 v[112:115], v149 offset:2048
    v_mfma_f32_16x16x32_bf16 v[4:7], v[96:99], v[72:75], v[4:7]
    ds_read_b128 v[116:119], v149 offset:4096
    v_mfma_f32_16x16x32_bf16 v[20:23], v[96:99], v[76:79], v[20:23]
    ds_read_b128 v[120:123], v149 offset:6144
    v_mfma_f32_16x16x32_bf16 v[36:39], v[96:99], v[80:83], v[36:39]
    ds_read_b64_tr_b16 v[132:133], v145 offset:15360
    v_mfma_f32_16x16x32_bf16 v[52:55], v[96:99], v[84:87], v[52:55]
    ds_read_b64_tr_b16 v[134:135], v145 offset:19200
    v_mfma_f32_16x16x32_bf16 v[8:11], v[100:103], v[72:75], v[8:11]
    ds_read_b64_tr_b16 v[136:137], v146 offset:15360
    v_mfma_f32_16x16x32_bf16 v[24:27], v[100:103], v[76:79], v[24:27]
    ds_read_b64_tr_b16 v[138:139], v146 offset:19200
    v_mfma_f32_16x16x32_bf16 v[40:43], v[100:103], v[80:83], v[40:43]
    ds_read_b64_tr_b16 v[140:141], v147 offset:15360
    v_mfma_f32_16x16x32_bf16 v[56:59], v[100:103], v[84:87], v[56:59]
    ds_read_b64_tr_b16 v[142:143], v147 offset:19200
    v_mfma_f32_16x16x32_bf16 v[12:15], v[104:107], v[72:75], v[12:15]
    v_mfma_f32_16x16x32_bf16 v[28:31], v[104:107], v[76:79], v[28:31]
    v_mfma_f32_16x16x32_bf16 v[44:47], v[104:107], v[80:83], v[44:47]
    v_mfma_f32_16x16x32_bf16 v[60:63], v[104:107], v[84:87], v[60:63]
    s_cmp_eq_u32 s77, 98304
    s_cselect_b32 s78, 4294868992, s49
    s_add_u32 s77, s77, s78
    s_waitcnt lgkmcnt(0)
    s_barrier
    v_mfma_f32_16x16x32_bf16 v[0:3], v[128:131], v[108:111], v[0:3]
    v_add_u32 v144, s78, v144
    v_add_u32 v148, s78, v148
    v_mfma_f32_16x16x32_bf16 v[16:19], v[128:131], v[112:115], v[16:19]
    ds_read_b64_tr_b16 v[92:93], v144 offset:0
    ds_read_b64_tr_b16 v[94:95], v144 offset:3840
    v_mfma_f32_16x16x32_bf16 v[32:35], v[128:131], v[116:119], v[32:35]
    ds_read_b128 v[72:75], v148 offset:0
    ds_read_b128 v[76:79], v148 offset:2048
    v_mfma_f32_16x16x32_bf16 v[48:51], v[128:131], v[120:123], v[48:51]
    ds_read_b128 v[80:83], v148 offset:4096
    ds_read_b128 v[84:87], v148 offset:6144
    v_mfma_f32_16x16x32_bf16 v[4:7], v[132:135], v[108:111], v[4:7]
    v_add_u32 v145, s78, v145
    ds_read_b64_tr_b16 v[96:97], v145 offset:0
    v_mfma_f32_16x16x32_bf16 v[20:23], v[132:135], v[112:115], v[20:23]
    ds_read_b64_tr_b16 v[98:99], v145 offset:3840
    v_add_u32 v146, s78, v146
    v_mfma_f32_16x16x32_bf16 v[36:39], v[132:135], v[116:119], v[36:39]
    ds_read_b64_tr_b16 v[100:101], v146 offset:0
    ds_read_b64_tr_b16 v[102:103], v146 offset:3840
    v_mfma_f32_16x16x32_bf16 v[52:55], v[132:135], v[120:123], v[52:55]
    v_add_u32 v147, s78, v147
    ds_read_b64_tr_b16 v[104:105], v147 offset:0
    v_mfma_f32_16x16x32_bf16 v[8:11], v[136:139], v[108:111], v[8:11]
    ds_read_b64_tr_b16 v[106:107], v147 offset:3840
    v_mfma_f32_16x16x32_bf16 v[24:27], v[136:139], v[112:115], v[24:27]
    v_add_u32 v149, s78, v149
    v_mfma_f32_16x16x32_bf16 v[40:43], v[136:139], v[116:119], v[40:43]
    v_mfma_f32_16x16x32_bf16 v[56:59], v[136:139], v[120:123], v[56:59]
    v_mfma_f32_16x16x32_bf16 v[12:15], v[140:143], v[108:111], v[12:15]
    v_mfma_f32_16x16x32_bf16 v[28:31], v[140:143], v[112:115], v[28:31]
    v_mfma_f32_16x16x32_bf16 v[44:47], v[140:143], v[116:119], v[44:47]
    v_mfma_f32_16x16x32_bf16 v[60:63], v[140:143], v[120:123], v[60:63]
    s_add_u32 s76, s76, 1
    s_cmp_eq_u32 s76, 9
    s_cbranch_scc0 gated_mix__sliding_local_dilated__dense_activation_mish__prompt_kernel_c4_loop_ng
    s_nop 7
    s_call_b64 s[88:89], gated_mix__sliding_local_dilated__dense_activation_mish__prompt_kernel_auxg
gated_mix__sliding_local_dilated__dense_activation_mish__prompt_kernel_c4_loop_ng:
    s_cmp_lt_u32 s76, 10
    s_cbranch_scc1 gated_mix__sliding_local_dilated__dense_activation_mish__prompt_kernel_c4_loop
    s_waitcnt lgkmcnt(0)
    s_setprio 2
    s_cmp_eq_u32 s51, 1
    s_cbranch_scc1 gated_mix__sliding_local_dilated__dense_activation_mish__prompt_kernel_epiB4
    v_and_b32 v154, 15, v153
    v_lshrrev_b32 v155, 4, v153
    v_mul_u32_u24 v154, 488, v154
    v_lshl_add_u32 v154, v155, 3, v154
    s_lshl_b32 s60, s59, 5
    v_add_u32 v154, s60, v154
    s_lshl_b32 s60, s57, 2
    s_add_u32 s60, s60, 1
    s_mul_i32 s60, s60, 7808
    v_add_u32 v155, s60, v154
    v_cvt_pk_bf16_f32 v72, v0, v1
    v_cvt_pk_bf16_f32 v73, v2, v3
    ds_write_b64 v155, v[72:73] offset:0
    v_cvt_pk_bf16_f32 v74, v16, v17
    v_cvt_pk_bf16_f32 v75, v18, v19
    ds_write_b64 v155, v[74:75] offset:7808
    v_cvt_pk_bf16_f32 v76, v32, v33
    v_cvt_pk_bf16_f32 v77, v34, v35
    ds_write_b64 v155, v[76:77] offset:15616
    v_cvt_pk_bf16_f32 v78, v48, v49
    v_cvt_pk_bf16_f32 v79, v50, v51
    ds_write_b64 v155, v[78:79] offset:23424
    v_cvt_pk_bf16_f32 v80, v4, v5
    v_cvt_pk_bf16_f32 v81, v6, v7
    ds_write_b64 v155, v[80:81] offset:32
    v_cvt_pk_bf16_f32 v82, v20, v21
    v_cvt_pk_bf16_f32 v83, v22, v23
    ds_write_b64 v155, v[82:83] offset:7840
    v_cvt_pk_bf16_f32 v84, v36, v37
    v_cvt_pk_bf16_f32 v85, v38, v39
    ds_write_b64 v155, v[84:85] offset:15648
    v_cvt_pk_bf16_f32 v86, v52, v53
    v_cvt_pk_bf16_f32 v87, v54, v55
    ds_write_b64 v155, v[86:87] offset:23456
    v_cvt_pk_bf16_f32 v88, v8, v9
    v_cvt_pk_bf16_f32 v89, v10, v11
    ds_write_b64 v155, v[88:89] offset:64
    v_cvt_pk_bf16_f32 v90, v24, v25
    v_cvt_pk_bf16_f32 v91, v26, v27
    ds_write_b64 v155, v[90:91] offset:7872
    v_cvt_pk_bf16_f32 v92, v40, v41
    v_cvt_pk_bf16_f32 v93, v42, v43
    ds_write_b64 v155, v[92:93] offset:15680
    v_cvt_pk_bf16_f32 v94, v56, v57
    v_cvt_pk_bf16_f32 v95, v58, v59
    ds_write_b64 v155, v[94:95] offset:23488
    v_cvt_pk_bf16_f32 v96, v12, v13
    v_cvt_pk_bf16_f32 v97, v14, v15
    ds_write_b64 v155, v[96:97] offset:96
    v_cvt_pk_bf16_f32 v98, v28, v29
    v_cvt_pk_bf16_f32 v99, v30, v31
    ds_write_b64 v155, v[98:99] offset:7904
    v_cvt_pk_bf16_f32 v100, v44, v45
    v_cvt_pk_bf16_f32 v101, v46, v47
    ds_write_b64 v155, v[100:101] offset:15712
    v_cvt_pk_bf16_f32 v102, v60, v61
    v_cvt_pk_bf16_f32 v103, v62, v63
    ds_write_b64 v155, v[102:103] offset:23520
    s_branch gated_mix__sliding_local_dilated__dense_activation_mish__prompt_kernel_attn
gated_mix__sliding_local_dilated__dense_activation_mish__prompt_kernel_c4a:
    s_barrier
    ds_read_b64_tr_b16 v[92:93], v144 offset:0
    ds_read_b64_tr_b16 v[94:95], v144 offset:3840
    ds_read_b128 v[72:75], v148 offset:0
    ds_read_b128 v[76:79], v148 offset:2048
    ds_read_b128 v[80:83], v148 offset:4096
    ds_read_b128 v[84:87], v148 offset:6144
    ds_read_b64_tr_b16 v[96:97], v145 offset:0
    ds_read_b64_tr_b16 v[98:99], v145 offset:3840
    ds_read_b64_tr_b16 v[100:101], v146 offset:0
    ds_read_b64_tr_b16 v[102:103], v146 offset:3840
    ds_read_b64_tr_b16 v[104:105], v147 offset:0
    ds_read_b64_tr_b16 v[106:107], v147 offset:3840
    ds_read_b128 v[88:91], v150
gated_mix__sliding_local_dilated__dense_activation_mish__prompt_kernel_c4a_loop:
    s_waitcnt lgkmcnt(0)
    v_mfma_f32_16x16x32_bf16 v[0:3], v[92:95], v[72:75], v[0:3]
    ds_read_b64_tr_b16 v[128:129], v144 offset:15360
    v_mfma_f32_16x16x32_bf16 v[16:19], v[92:95], v[76:79], v[16:19]
    ds_read_b64_tr_b16 v[130:131], v144 offset:19200
    v_mfma_f32_16x16x32_bf16 v[32:35], v[92:95], v[80:83], v[32:35]
    ds_read_b128 v[108:111], v149 offset:0
    v_mfma_f32_16x16x32_bf16 v[48:51], v[92:95], v[84:87], v[48:51]
    ds_read_b128 v[112:115], v149 offset:2048
    v_mfma_f32_16x16x32_bf16 v[4:7], v[96:99], v[72:75], v[4:7]
    ds_read_b128 v[116:119], v149 offset:4096
    v_mfma_f32_16x16x32_bf16 v[20:23], v[96:99], v[76:79], v[20:23]
    ds_read_b128 v[120:123], v149 offset:6144
    v_mfma_f32_16x16x32_bf16 v[36:39], v[96:99], v[80:83], v[36:39]
    ds_read_b64_tr_b16 v[132:133], v145 offset:15360
    v_mfma_f32_16x16x32_bf16 v[52:55], v[96:99], v[84:87], v[52:55]
    ds_read_b64_tr_b16 v[134:135], v145 offset:19200
    v_mfma_f32_16x16x32_bf16 v[8:11], v[100:103], v[72:75], v[8:11]
    ds_read_b64_tr_b16 v[136:137], v146 offset:15360
    v_mfma_f32_16x16x32_bf16 v[24:27], v[100:103], v[76:79], v[24:27]
    ds_read_b64_tr_b16 v[138:139], v146 offset:19200
    v_mfma_f32_16x16x32_bf16 v[40:43], v[100:103], v[80:83], v[40:43]
    ds_read_b64_tr_b16 v[140:141], v147 offset:15360
    v_mfma_f32_16x16x32_bf16 v[56:59], v[100:103], v[84:87], v[56:59]
    ds_read_b64_tr_b16 v[142:143], v147 offset:19200
    v_mfma_f32_16x16x32_bf16 v[12:15], v[104:107], v[72:75], v[12:15]
    ds_read_b128 v[124:127], v151
    v_mfma_f32_16x16x32_bf16 v[28:31], v[104:107], v[76:79], v[28:31]
    v_mfma_f32_16x16x32_bf16 v[44:47], v[104:107], v[80:83], v[44:47]
    v_mfma_f32_16x16x32_bf16 v[60:63], v[104:107], v[84:87], v[60:63]
    v_mfma_f32_16x16x32_bf16 v[64:67], v[92:95], v[88:91], v[64:67]
    v_mfma_f32_16x16x32_bf16 v[68:71], v[96:99], v[88:91], v[68:71]
    s_cmp_eq_u32 s77, 98304
    s_cselect_b32 s78, 4294868992, s49
    s_add_u32 s77, s77, s78
    s_waitcnt lgkmcnt(0)
    s_barrier
    v_mfma_f32_16x16x32_bf16 v[0:3], v[128:131], v[108:111], v[0:3]
    v_add_u32 v144, s78, v144
    v_add_u32 v148, s78, v148
    v_mfma_f32_16x16x32_bf16 v[16:19], v[128:131], v[112:115], v[16:19]
    ds_read_b64_tr_b16 v[92:93], v144 offset:0
    ds_read_b64_tr_b16 v[94:95], v144 offset:3840
    v_mfma_f32_16x16x32_bf16 v[32:35], v[128:131], v[116:119], v[32:35]
    ds_read_b128 v[72:75], v148 offset:0
    ds_read_b128 v[76:79], v148 offset:2048
    v_mfma_f32_16x16x32_bf16 v[48:51], v[128:131], v[120:123], v[48:51]
    ds_read_b128 v[80:83], v148 offset:4096
    ds_read_b128 v[84:87], v148 offset:6144
    v_mfma_f32_16x16x32_bf16 v[4:7], v[132:135], v[108:111], v[4:7]
    v_add_u32 v145, s78, v145
    ds_read_b64_tr_b16 v[96:97], v145 offset:0
    v_mfma_f32_16x16x32_bf16 v[20:23], v[132:135], v[112:115], v[20:23]
    ds_read_b64_tr_b16 v[98:99], v145 offset:3840
    v_add_u32 v146, s78, v146
    v_mfma_f32_16x16x32_bf16 v[36:39], v[132:135], v[116:119], v[36:39]
    ds_read_b64_tr_b16 v[100:101], v146 offset:0
    ds_read_b64_tr_b16 v[102:103], v146 offset:3840
    v_mfma_f32_16x16x32_bf16 v[52:55], v[132:135], v[120:123], v[52:55]
    v_add_u32 v147, s78, v147
    ds_read_b64_tr_b16 v[104:105], v147 offset:0
    v_mfma_f32_16x16x32_bf16 v[8:11], v[136:139], v[108:111], v[8:11]
    ds_read_b64_tr_b16 v[106:107], v147 offset:3840
    v_add_u32 v150, s78, v150
    v_mfma_f32_16x16x32_bf16 v[24:27], v[136:139], v[112:115], v[24:27]
    ds_read_b128 v[88:91], v150
    v_mfma_f32_16x16x32_bf16 v[40:43], v[136:139], v[116:119], v[40:43]
    v_add_u32 v149, s78, v149
    v_add_u32 v151, s78, v151
    v_mfma_f32_16x16x32_bf16 v[56:59], v[136:139], v[120:123], v[56:59]
    v_mfma_f32_16x16x32_bf16 v[12:15], v[140:143], v[108:111], v[12:15]
    v_mfma_f32_16x16x32_bf16 v[28:31], v[140:143], v[112:115], v[28:31]
    v_mfma_f32_16x16x32_bf16 v[44:47], v[140:143], v[116:119], v[44:47]
    v_mfma_f32_16x16x32_bf16 v[60:63], v[140:143], v[120:123], v[60:63]
    v_mfma_f32_16x16x32_bf16 v[64:67], v[128:131], v[124:127], v[64:67]
    v_mfma_f32_16x16x32_bf16 v[68:71], v[132:135], v[124:127], v[68:71]
    s_add_u32 s76, s76, 1
    s_cmp_eq_u32 s76, 9
    s_cbranch_scc0 gated_mix__sliding_local_dilated__dense_activation_mish__prompt_kernel_c4a_loop_ng
    s_nop 7
    s_call_b64 s[88:89], gated_mix__sliding_local_dilated__dense_activation_mish__prompt_kernel_auxg
gated_mix__sliding_local_dilated__dense_activation_mish__prompt_kernel_c4a_loop_ng:
    s_cmp_lt_u32 s76, 10
    s_cbranch_scc1 gated_mix__sliding_local_dilated__dense_activation_mish__prompt_kernel_c4a_loop
    s_waitcnt lgkmcnt(0)
    s_setprio 2
    v_and_b32 v154, 15, v153
    v_lshrrev_b32 v155, 4, v153
    v_mul_u32_u24 v154, 488, v154
    v_lshl_add_u32 v154, v155, 3, v154
    s_lshl_b32 s60, s59, 5
    v_add_u32 v154, s60, v154
    s_lshl_b32 s60, s57, 2
    s_add_u32 s60, s60, 1
    s_mul_i32 s60, s60, 7808
    v_add_u32 v155, s60, v154
    v_cvt_pk_bf16_f32 v72, v0, v1
    v_cvt_pk_bf16_f32 v73, v2, v3
    ds_write_b64 v155, v[72:73] offset:0
    v_cvt_pk_bf16_f32 v74, v16, v17
    v_cvt_pk_bf16_f32 v75, v18, v19
    ds_write_b64 v155, v[74:75] offset:7808
    v_cvt_pk_bf16_f32 v76, v32, v33
    v_cvt_pk_bf16_f32 v77, v34, v35
    ds_write_b64 v155, v[76:77] offset:15616
    v_cvt_pk_bf16_f32 v78, v48, v49
    v_cvt_pk_bf16_f32 v79, v50, v51
    ds_write_b64 v155, v[78:79] offset:23424
    v_cvt_pk_bf16_f32 v80, v4, v5
    v_cvt_pk_bf16_f32 v81, v6, v7
    ds_write_b64 v155, v[80:81] offset:32
    v_cvt_pk_bf16_f32 v82, v20, v21
    v_cvt_pk_bf16_f32 v83, v22, v23
    ds_write_b64 v155, v[82:83] offset:7840
    v_cvt_pk_bf16_f32 v84, v36, v37
    v_cvt_pk_bf16_f32 v85, v38, v39
    ds_write_b64 v155, v[84:85] offset:15648
    v_cvt_pk_bf16_f32 v86, v52, v53
    v_cvt_pk_bf16_f32 v87, v54, v55
    ds_write_b64 v155, v[86:87] offset:23456
    v_cvt_pk_bf16_f32 v88, v8, v9
    v_cvt_pk_bf16_f32 v89, v10, v11
    ds_write_b64 v155, v[88:89] offset:64
    v_cvt_pk_bf16_f32 v90, v24, v25
    v_cvt_pk_bf16_f32 v91, v26, v27
    ds_write_b64 v155, v[90:91] offset:7872
    v_cvt_pk_bf16_f32 v92, v40, v41
    v_cvt_pk_bf16_f32 v93, v42, v43
    ds_write_b64 v155, v[92:93] offset:15680
    v_cvt_pk_bf16_f32 v94, v56, v57
    v_cvt_pk_bf16_f32 v95, v58, v59
    ds_write_b64 v155, v[94:95] offset:23488
    v_cvt_pk_bf16_f32 v96, v12, v13
    v_cvt_pk_bf16_f32 v97, v14, v15
    ds_write_b64 v155, v[96:97] offset:96
    v_cvt_pk_bf16_f32 v98, v28, v29
    v_cvt_pk_bf16_f32 v99, v30, v31
    ds_write_b64 v155, v[98:99] offset:7904
    v_cvt_pk_bf16_f32 v100, v44, v45
    v_cvt_pk_bf16_f32 v101, v46, v47
    ds_write_b64 v155, v[100:101] offset:15712
    v_cvt_pk_bf16_f32 v102, v60, v61
    v_cvt_pk_bf16_f32 v103, v62, v63
    ds_write_b64 v155, v[102:103] offset:23520
    v_cvt_pk_bf16_f32 v104, v64, v65
    v_cvt_pk_bf16_f32 v105, v66, v67
    ds_write_b64 v154, v[104:105] offset:0
    v_cvt_pk_bf16_f32 v106, v68, v69
    v_cvt_pk_bf16_f32 v107, v70, v71
    ds_write_b64 v154, v[106:107] offset:32
    s_branch gated_mix__sliding_local_dilated__dense_activation_mish__prompt_kernel_attn
gated_mix__sliding_local_dilated__dense_activation_mish__prompt_kernel_c4b:
    s_barrier
    ds_read_b64_tr_b16 v[92:93], v144 offset:0
    ds_read_b64_tr_b16 v[94:95], v144 offset:3840
    ds_read_b128 v[72:75], v148 offset:0
    ds_read_b128 v[76:79], v148 offset:2048
    ds_read_b128 v[80:83], v148 offset:4096
    ds_read_b128 v[84:87], v148 offset:6144
    ds_read_b64_tr_b16 v[96:97], v145 offset:0
    ds_read_b64_tr_b16 v[98:99], v145 offset:3840
    ds_read_b64_tr_b16 v[100:101], v146 offset:0
    ds_read_b64_tr_b16 v[102:103], v146 offset:3840
    ds_read_b64_tr_b16 v[104:105], v147 offset:0
    ds_read_b64_tr_b16 v[106:107], v147 offset:3840
    ds_read_b128 v[88:91], v150
gated_mix__sliding_local_dilated__dense_activation_mish__prompt_kernel_c4b_loop:
    s_waitcnt lgkmcnt(0)
    v_mfma_f32_16x16x32_bf16 v[0:3], v[92:95], v[72:75], v[0:3]
    ds_read_b64_tr_b16 v[128:129], v144 offset:15360
    v_mfma_f32_16x16x32_bf16 v[16:19], v[92:95], v[76:79], v[16:19]
    ds_read_b64_tr_b16 v[130:131], v144 offset:19200
    v_mfma_f32_16x16x32_bf16 v[32:35], v[92:95], v[80:83], v[32:35]
    ds_read_b128 v[108:111], v149 offset:0
    v_mfma_f32_16x16x32_bf16 v[48:51], v[92:95], v[84:87], v[48:51]
    ds_read_b128 v[112:115], v149 offset:2048
    v_mfma_f32_16x16x32_bf16 v[4:7], v[96:99], v[72:75], v[4:7]
    ds_read_b128 v[116:119], v149 offset:4096
    v_mfma_f32_16x16x32_bf16 v[20:23], v[96:99], v[76:79], v[20:23]
    ds_read_b128 v[120:123], v149 offset:6144
    v_mfma_f32_16x16x32_bf16 v[36:39], v[96:99], v[80:83], v[36:39]
    ds_read_b64_tr_b16 v[132:133], v145 offset:15360
    v_mfma_f32_16x16x32_bf16 v[52:55], v[96:99], v[84:87], v[52:55]
    ds_read_b64_tr_b16 v[134:135], v145 offset:19200
    v_mfma_f32_16x16x32_bf16 v[8:11], v[100:103], v[72:75], v[8:11]
    ds_read_b64_tr_b16 v[136:137], v146 offset:15360
    v_mfma_f32_16x16x32_bf16 v[24:27], v[100:103], v[76:79], v[24:27]
    ds_read_b64_tr_b16 v[138:139], v146 offset:19200
    v_mfma_f32_16x16x32_bf16 v[40:43], v[100:103], v[80:83], v[40:43]
    ds_read_b64_tr_b16 v[140:141], v147 offset:15360
    v_mfma_f32_16x16x32_bf16 v[56:59], v[100:103], v[84:87], v[56:59]
    ds_read_b64_tr_b16 v[142:143], v147 offset:19200
    v_mfma_f32_16x16x32_bf16 v[12:15], v[104:107], v[72:75], v[12:15]
    ds_read_b128 v[124:127], v151
    v_mfma_f32_16x16x32_bf16 v[28:31], v[104:107], v[76:79], v[28:31]
    v_mfma_f32_16x16x32_bf16 v[44:47], v[104:107], v[80:83], v[44:47]
    v_mfma_f32_16x16x32_bf16 v[60:63], v[104:107], v[84:87], v[60:63]
    v_mfma_f32_16x16x32_bf16 v[64:67], v[100:103], v[88:91], v[64:67]
    v_mfma_f32_16x16x32_bf16 v[68:71], v[104:107], v[88:91], v[68:71]
    s_cmp_eq_u32 s77, 98304
    s_cselect_b32 s78, 4294868992, s49
    s_add_u32 s77, s77, s78
    s_waitcnt lgkmcnt(0)
    s_barrier
    v_mfma_f32_16x16x32_bf16 v[0:3], v[128:131], v[108:111], v[0:3]
    v_add_u32 v144, s78, v144
    v_add_u32 v148, s78, v148
    v_mfma_f32_16x16x32_bf16 v[16:19], v[128:131], v[112:115], v[16:19]
    ds_read_b64_tr_b16 v[92:93], v144 offset:0
    ds_read_b64_tr_b16 v[94:95], v144 offset:3840
    v_mfma_f32_16x16x32_bf16 v[32:35], v[128:131], v[116:119], v[32:35]
    ds_read_b128 v[72:75], v148 offset:0
    ds_read_b128 v[76:79], v148 offset:2048
    v_mfma_f32_16x16x32_bf16 v[48:51], v[128:131], v[120:123], v[48:51]
    ds_read_b128 v[80:83], v148 offset:4096
    ds_read_b128 v[84:87], v148 offset:6144
    v_mfma_f32_16x16x32_bf16 v[4:7], v[132:135], v[108:111], v[4:7]
    v_add_u32 v145, s78, v145
    ds_read_b64_tr_b16 v[96:97], v145 offset:0
    v_mfma_f32_16x16x32_bf16 v[20:23], v[132:135], v[112:115], v[20:23]
    ds_read_b64_tr_b16 v[98:99], v145 offset:3840
    v_add_u32 v146, s78, v146
    v_mfma_f32_16x16x32_bf16 v[36:39], v[132:135], v[116:119], v[36:39]
    ds_read_b64_tr_b16 v[100:101], v146 offset:0
    ds_read_b64_tr_b16 v[102:103], v146 offset:3840
    v_mfma_f32_16x16x32_bf16 v[52:55], v[132:135], v[120:123], v[52:55]
    v_add_u32 v147, s78, v147
    ds_read_b64_tr_b16 v[104:105], v147 offset:0
    v_mfma_f32_16x16x32_bf16 v[8:11], v[136:139], v[108:111], v[8:11]
    ds_read_b64_tr_b16 v[106:107], v147 offset:3840
    v_add_u32 v150, s78, v150
    v_mfma_f32_16x16x32_bf16 v[24:27], v[136:139], v[112:115], v[24:27]
    ds_read_b128 v[88:91], v150
    v_mfma_f32_16x16x32_bf16 v[40:43], v[136:139], v[116:119], v[40:43]
    v_add_u32 v149, s78, v149
    v_add_u32 v151, s78, v151
    v_mfma_f32_16x16x32_bf16 v[56:59], v[136:139], v[120:123], v[56:59]
    v_mfma_f32_16x16x32_bf16 v[12:15], v[140:143], v[108:111], v[12:15]
    v_mfma_f32_16x16x32_bf16 v[28:31], v[140:143], v[112:115], v[28:31]
    v_mfma_f32_16x16x32_bf16 v[44:47], v[140:143], v[116:119], v[44:47]
    v_mfma_f32_16x16x32_bf16 v[60:63], v[140:143], v[120:123], v[60:63]
    v_mfma_f32_16x16x32_bf16 v[64:67], v[136:139], v[124:127], v[64:67]
    v_mfma_f32_16x16x32_bf16 v[68:71], v[140:143], v[124:127], v[68:71]
    s_add_u32 s76, s76, 1
    s_cmp_eq_u32 s76, 9
    s_cbranch_scc0 gated_mix__sliding_local_dilated__dense_activation_mish__prompt_kernel_c4b_loop_ng
    s_nop 7
    s_call_b64 s[88:89], gated_mix__sliding_local_dilated__dense_activation_mish__prompt_kernel_auxg
gated_mix__sliding_local_dilated__dense_activation_mish__prompt_kernel_c4b_loop_ng:
    s_cmp_lt_u32 s76, 10
    s_cbranch_scc1 gated_mix__sliding_local_dilated__dense_activation_mish__prompt_kernel_c4b_loop
    s_waitcnt lgkmcnt(0)
    s_setprio 2
    v_and_b32 v154, 15, v153
    v_lshrrev_b32 v155, 4, v153
    v_mul_u32_u24 v154, 488, v154
    v_lshl_add_u32 v154, v155, 3, v154
    s_lshl_b32 s60, s59, 5
    v_add_u32 v154, s60, v154
    s_lshl_b32 s60, s57, 2
    s_add_u32 s60, s60, 1
    s_mul_i32 s60, s60, 7808
    v_add_u32 v155, s60, v154
    v_cvt_pk_bf16_f32 v72, v0, v1
    v_cvt_pk_bf16_f32 v73, v2, v3
    ds_write_b64 v155, v[72:73] offset:0
    v_cvt_pk_bf16_f32 v74, v16, v17
    v_cvt_pk_bf16_f32 v75, v18, v19
    ds_write_b64 v155, v[74:75] offset:7808
    v_cvt_pk_bf16_f32 v76, v32, v33
    v_cvt_pk_bf16_f32 v77, v34, v35
    ds_write_b64 v155, v[76:77] offset:15616
    v_cvt_pk_bf16_f32 v78, v48, v49
    v_cvt_pk_bf16_f32 v79, v50, v51
    ds_write_b64 v155, v[78:79] offset:23424
    v_cvt_pk_bf16_f32 v80, v4, v5
    v_cvt_pk_bf16_f32 v81, v6, v7
    ds_write_b64 v155, v[80:81] offset:32
    v_cvt_pk_bf16_f32 v82, v20, v21
    v_cvt_pk_bf16_f32 v83, v22, v23
    ds_write_b64 v155, v[82:83] offset:7840
    v_cvt_pk_bf16_f32 v84, v36, v37
    v_cvt_pk_bf16_f32 v85, v38, v39
    ds_write_b64 v155, v[84:85] offset:15648
    v_cvt_pk_bf16_f32 v86, v52, v53
    v_cvt_pk_bf16_f32 v87, v54, v55
    ds_write_b64 v155, v[86:87] offset:23456
    v_cvt_pk_bf16_f32 v88, v8, v9
    v_cvt_pk_bf16_f32 v89, v10, v11
    ds_write_b64 v155, v[88:89] offset:64
    v_cvt_pk_bf16_f32 v90, v24, v25
    v_cvt_pk_bf16_f32 v91, v26, v27
    ds_write_b64 v155, v[90:91] offset:7872
    v_cvt_pk_bf16_f32 v92, v40, v41
    v_cvt_pk_bf16_f32 v93, v42, v43
    ds_write_b64 v155, v[92:93] offset:15680
    v_cvt_pk_bf16_f32 v94, v56, v57
    v_cvt_pk_bf16_f32 v95, v58, v59
    ds_write_b64 v155, v[94:95] offset:23488
    v_cvt_pk_bf16_f32 v96, v12, v13
    v_cvt_pk_bf16_f32 v97, v14, v15
    ds_write_b64 v155, v[96:97] offset:96
    v_cvt_pk_bf16_f32 v98, v28, v29
    v_cvt_pk_bf16_f32 v99, v30, v31
    ds_write_b64 v155, v[98:99] offset:7904
    v_cvt_pk_bf16_f32 v100, v44, v45
    v_cvt_pk_bf16_f32 v101, v46, v47
    ds_write_b64 v155, v[100:101] offset:15712
    v_cvt_pk_bf16_f32 v102, v60, v61
    v_cvt_pk_bf16_f32 v103, v62, v63
    ds_write_b64 v155, v[102:103] offset:23520
    v_cvt_pk_bf16_f32 v104, v64, v65
    v_cvt_pk_bf16_f32 v105, v66, v67
    ds_write_b64 v154, v[104:105] offset:64
    v_cvt_pk_bf16_f32 v106, v68, v69
    v_cvt_pk_bf16_f32 v107, v70, v71
    ds_write_b64 v154, v[106:107] offset:96
    s_branch gated_mix__sliding_local_dilated__dense_activation_mish__prompt_kernel_attn
gated_mix__sliding_local_dilated__dense_activation_mish__prompt_kernel_c4c:
    s_barrier
    ds_read_b64_tr_b16 v[92:93], v144 offset:0
    ds_read_b64_tr_b16 v[94:95], v144 offset:3840
    ds_read_b128 v[72:75], v148 offset:0
    ds_read_b128 v[76:79], v148 offset:2048
    ds_read_b128 v[80:83], v148 offset:4096
    ds_read_b128 v[84:87], v148 offset:6144
    ds_read_b64_tr_b16 v[96:97], v145 offset:0
    ds_read_b64_tr_b16 v[98:99], v145 offset:3840
    ds_read_b64_tr_b16 v[100:101], v146 offset:0
    ds_read_b64_tr_b16 v[102:103], v146 offset:3840
    ds_read_b64_tr_b16 v[104:105], v147 offset:0
    ds_read_b64_tr_b16 v[106:107], v147 offset:3840
    ds_read_b128 v[88:91], v150
gated_mix__sliding_local_dilated__dense_activation_mish__prompt_kernel_c4c_loop:
    s_waitcnt lgkmcnt(0)
    v_mfma_f32_16x16x32_bf16 v[0:3], v[92:95], v[72:75], v[0:3]
    ds_read_b64_tr_b16 v[128:129], v144 offset:15360
    v_mfma_f32_16x16x32_bf16 v[16:19], v[92:95], v[76:79], v[16:19]
    ds_read_b64_tr_b16 v[130:131], v144 offset:19200
    v_mfma_f32_16x16x32_bf16 v[32:35], v[92:95], v[80:83], v[32:35]
    ds_read_b128 v[108:111], v149 offset:0
    v_mfma_f32_16x16x32_bf16 v[48:51], v[92:95], v[84:87], v[48:51]
    ds_read_b128 v[112:115], v149 offset:2048
    v_mfma_f32_16x16x32_bf16 v[4:7], v[96:99], v[72:75], v[4:7]
    ds_read_b128 v[116:119], v149 offset:4096
    v_mfma_f32_16x16x32_bf16 v[20:23], v[96:99], v[76:79], v[20:23]
    ds_read_b128 v[120:123], v149 offset:6144
    v_mfma_f32_16x16x32_bf16 v[36:39], v[96:99], v[80:83], v[36:39]
    ds_read_b64_tr_b16 v[132:133], v145 offset:15360
    v_mfma_f32_16x16x32_bf16 v[52:55], v[96:99], v[84:87], v[52:55]
    ds_read_b64_tr_b16 v[134:135], v145 offset:19200
    v_mfma_f32_16x16x32_bf16 v[8:11], v[100:103], v[72:75], v[8:11]
    ds_read_b64_tr_b16 v[136:137], v146 offset:15360
    v_mfma_f32_16x16x32_bf16 v[24:27], v[100:103], v[76:79], v[24:27]
    ds_read_b64_tr_b16 v[138:139], v146 offset:19200
    v_mfma_f32_16x16x32_bf16 v[40:43], v[100:103], v[80:83], v[40:43]
    ds_read_b64_tr_b16 v[140:141], v147 offset:15360
    v_mfma_f32_16x16x32_bf16 v[56:59], v[100:103], v[84:87], v[56:59]
    ds_read_b64_tr_b16 v[142:143], v147 offset:19200
    v_mfma_f32_16x16x32_bf16 v[12:15], v[104:107], v[72:75], v[12:15]
    ds_read_b128 v[124:127], v151
    v_mfma_f32_16x16x32_bf16 v[28:31], v[104:107], v[76:79], v[28:31]
    v_mfma_f32_16x16x32_bf16 v[44:47], v[104:107], v[80:83], v[44:47]
    v_mfma_f32_16x16x32_bf16 v[60:63], v[104:107], v[84:87], v[60:63]
    v_mfma_f32_16x16x32_bf16 v[64:67], v[96:99], v[88:91], v[64:67]
    s_cmp_eq_u32 s77, 98304
    s_cselect_b32 s78, 4294868992, s49
    s_add_u32 s77, s77, s78
    s_waitcnt lgkmcnt(0)
    s_barrier
    v_mfma_f32_16x16x32_bf16 v[0:3], v[128:131], v[108:111], v[0:3]
    v_add_u32 v144, s78, v144
    v_add_u32 v148, s78, v148
    v_mfma_f32_16x16x32_bf16 v[16:19], v[128:131], v[112:115], v[16:19]
    ds_read_b64_tr_b16 v[92:93], v144 offset:0
    ds_read_b64_tr_b16 v[94:95], v144 offset:3840
    v_mfma_f32_16x16x32_bf16 v[32:35], v[128:131], v[116:119], v[32:35]
    ds_read_b128 v[72:75], v148 offset:0
    ds_read_b128 v[76:79], v148 offset:2048
    v_mfma_f32_16x16x32_bf16 v[48:51], v[128:131], v[120:123], v[48:51]
    ds_read_b128 v[80:83], v148 offset:4096
    ds_read_b128 v[84:87], v148 offset:6144
    v_mfma_f32_16x16x32_bf16 v[4:7], v[132:135], v[108:111], v[4:7]
    v_add_u32 v145, s78, v145
    ds_read_b64_tr_b16 v[96:97], v145 offset:0
    v_mfma_f32_16x16x32_bf16 v[20:23], v[132:135], v[112:115], v[20:23]
    ds_read_b64_tr_b16 v[98:99], v145 offset:3840
    v_add_u32 v146, s78, v146
    v_mfma_f32_16x16x32_bf16 v[36:39], v[132:135], v[116:119], v[36:39]
    ds_read_b64_tr_b16 v[100:101], v146 offset:0
    ds_read_b64_tr_b16 v[102:103], v146 offset:3840
    v_mfma_f32_16x16x32_bf16 v[52:55], v[132:135], v[120:123], v[52:55]
    v_add_u32 v147, s78, v147
    ds_read_b64_tr_b16 v[104:105], v147 offset:0
    v_mfma_f32_16x16x32_bf16 v[8:11], v[136:139], v[108:111], v[8:11]
    ds_read_b64_tr_b16 v[106:107], v147 offset:3840
    v_add_u32 v150, s78, v150
    v_mfma_f32_16x16x32_bf16 v[24:27], v[136:139], v[112:115], v[24:27]
    ds_read_b128 v[88:91], v150
    v_mfma_f32_16x16x32_bf16 v[40:43], v[136:139], v[116:119], v[40:43]
    v_add_u32 v149, s78, v149
    v_add_u32 v151, s78, v151
    v_mfma_f32_16x16x32_bf16 v[56:59], v[136:139], v[120:123], v[56:59]
    v_mfma_f32_16x16x32_bf16 v[12:15], v[140:143], v[108:111], v[12:15]
    v_mfma_f32_16x16x32_bf16 v[28:31], v[140:143], v[112:115], v[28:31]
    v_mfma_f32_16x16x32_bf16 v[44:47], v[140:143], v[116:119], v[44:47]
    v_mfma_f32_16x16x32_bf16 v[60:63], v[140:143], v[120:123], v[60:63]
    v_mfma_f32_16x16x32_bf16 v[64:67], v[132:135], v[124:127], v[64:67]
    s_add_u32 s76, s76, 1
    s_cmp_eq_u32 s76, 9
    s_cbranch_scc0 gated_mix__sliding_local_dilated__dense_activation_mish__prompt_kernel_c4c_loop_ng
    s_nop 7
    s_call_b64 s[88:89], gated_mix__sliding_local_dilated__dense_activation_mish__prompt_kernel_auxg
gated_mix__sliding_local_dilated__dense_activation_mish__prompt_kernel_c4c_loop_ng:
    s_cmp_lt_u32 s76, 10
    s_cbranch_scc1 gated_mix__sliding_local_dilated__dense_activation_mish__prompt_kernel_c4c_loop
    s_waitcnt lgkmcnt(0)
    s_setprio 2
    v_and_b32 v154, 15, v153
    v_lshrrev_b32 v155, 4, v153
    v_mul_u32_u24 v154, 488, v154
    v_lshl_add_u32 v154, v155, 3, v154
    s_lshl_b32 s60, s59, 5
    v_add_u32 v154, s60, v154
    s_lshl_b32 s60, s57, 2
    s_add_u32 s60, s60, 1
    s_mul_i32 s60, s60, 7808
    v_add_u32 v155, s60, v154
    v_cvt_pk_bf16_f32 v72, v0, v1
    v_cvt_pk_bf16_f32 v73, v2, v3
    ds_write_b64 v155, v[72:73] offset:0
    v_cvt_pk_bf16_f32 v74, v16, v17
    v_cvt_pk_bf16_f32 v75, v18, v19
    ds_write_b64 v155, v[74:75] offset:7808
    v_cvt_pk_bf16_f32 v76, v32, v33
    v_cvt_pk_bf16_f32 v77, v34, v35
    ds_write_b64 v155, v[76:77] offset:15616
    v_cvt_pk_bf16_f32 v78, v48, v49
    v_cvt_pk_bf16_f32 v79, v50, v51
    ds_write_b64 v155, v[78:79] offset:23424
    v_cvt_pk_bf16_f32 v80, v4, v5
    v_cvt_pk_bf16_f32 v81, v6, v7
    ds_write_b64 v155, v[80:81] offset:32
    v_cvt_pk_bf16_f32 v82, v20, v21
    v_cvt_pk_bf16_f32 v83, v22, v23
    ds_write_b64 v155, v[82:83] offset:7840
    v_cvt_pk_bf16_f32 v84, v36, v37
    v_cvt_pk_bf16_f32 v85, v38, v39
    ds_write_b64 v155, v[84:85] offset:15648
    v_cvt_pk_bf16_f32 v86, v52, v53
    v_cvt_pk_bf16_f32 v87, v54, v55
    ds_write_b64 v155, v[86:87] offset:23456
    v_cvt_pk_bf16_f32 v88, v8, v9
    v_cvt_pk_bf16_f32 v89, v10, v11
    ds_write_b64 v155, v[88:89] offset:64
    v_cvt_pk_bf16_f32 v90, v24, v25
    v_cvt_pk_bf16_f32 v91, v26, v27
    ds_write_b64 v155, v[90:91] offset:7872
    v_cvt_pk_bf16_f32 v92, v40, v41
    v_cvt_pk_bf16_f32 v93, v42, v43
    ds_write_b64 v155, v[92:93] offset:15680
    v_cvt_pk_bf16_f32 v94, v56, v57
    v_cvt_pk_bf16_f32 v95, v58, v59
    ds_write_b64 v155, v[94:95] offset:23488
    v_cvt_pk_bf16_f32 v96, v12, v13
    v_cvt_pk_bf16_f32 v97, v14, v15
    ds_write_b64 v155, v[96:97] offset:96
    v_cvt_pk_bf16_f32 v98, v28, v29
    v_cvt_pk_bf16_f32 v99, v30, v31
    ds_write_b64 v155, v[98:99] offset:7904
    v_cvt_pk_bf16_f32 v100, v44, v45
    v_cvt_pk_bf16_f32 v101, v46, v47
    ds_write_b64 v155, v[100:101] offset:15712
    v_cvt_pk_bf16_f32 v102, v60, v61
    v_cvt_pk_bf16_f32 v103, v62, v63
    ds_write_b64 v155, v[102:103] offset:23520
    v_cvt_pk_bf16_f32 v104, v64, v65
    v_cvt_pk_bf16_f32 v105, v66, v67
    ds_write_b64 v154, v[104:105] offset:32
    s_branch gated_mix__sliding_local_dilated__dense_activation_mish__prompt_kernel_attn
gated_mix__sliding_local_dilated__dense_activation_mish__prompt_kernel_c3a:
    s_barrier
    ds_read_b64_tr_b16 v[92:93], v144 offset:0
    ds_read_b64_tr_b16 v[94:95], v144 offset:3840
    ds_read_b128 v[72:75], v148 offset:0
    ds_read_b128 v[76:79], v148 offset:2048
    ds_read_b128 v[80:83], v148 offset:4096
    ds_read_b128 v[84:87], v148 offset:6144
    ds_read_b64_tr_b16 v[96:97], v145 offset:0
    ds_read_b64_tr_b16 v[98:99], v145 offset:3840
    ds_read_b64_tr_b16 v[100:101], v146 offset:0
    ds_read_b64_tr_b16 v[102:103], v146 offset:3840
    ds_read_b128 v[88:91], v150
gated_mix__sliding_local_dilated__dense_activation_mish__prompt_kernel_c3a_loop:
    s_waitcnt lgkmcnt(0)
    v_mfma_f32_16x16x32_bf16 v[0:3], v[92:95], v[72:75], v[0:3]
    ds_read_b64_tr_b16 v[128:129], v144 offset:15360
    v_mfma_f32_16x16x32_bf16 v[16:19], v[92:95], v[76:79], v[16:19]
    ds_read_b64_tr_b16 v[130:131], v144 offset:19200
    v_mfma_f32_16x16x32_bf16 v[32:35], v[92:95], v[80:83], v[32:35]
    ds_read_b128 v[108:111], v149 offset:0
    v_mfma_f32_16x16x32_bf16 v[48:51], v[92:95], v[84:87], v[48:51]
    ds_read_b128 v[112:115], v149 offset:2048
    v_mfma_f32_16x16x32_bf16 v[4:7], v[96:99], v[72:75], v[4:7]
    ds_read_b128 v[116:119], v149 offset:4096
    v_mfma_f32_16x16x32_bf16 v[20:23], v[96:99], v[76:79], v[20:23]
    ds_read_b128 v[120:123], v149 offset:6144
    v_mfma_f32_16x16x32_bf16 v[36:39], v[96:99], v[80:83], v[36:39]
    ds_read_b64_tr_b16 v[132:133], v145 offset:15360
    v_mfma_f32_16x16x32_bf16 v[52:55], v[96:99], v[84:87], v[52:55]
    ds_read_b64_tr_b16 v[134:135], v145 offset:19200
    v_mfma_f32_16x16x32_bf16 v[8:11], v[100:103], v[72:75], v[8:11]
    ds_read_b64_tr_b16 v[136:137], v146 offset:15360
    v_mfma_f32_16x16x32_bf16 v[24:27], v[100:103], v[76:79], v[24:27]
    ds_read_b64_tr_b16 v[138:139], v146 offset:19200
    v_mfma_f32_16x16x32_bf16 v[40:43], v[100:103], v[80:83], v[40:43]
    ds_read_b128 v[124:127], v151
    v_mfma_f32_16x16x32_bf16 v[56:59], v[100:103], v[84:87], v[56:59]
    v_mfma_f32_16x16x32_bf16 v[64:67], v[92:95], v[88:91], v[64:67]
    v_mfma_f32_16x16x32_bf16 v[68:71], v[96:99], v[88:91], v[68:71]
    s_cmp_eq_u32 s77, 98304
    s_cselect_b32 s78, 4294868992, s49
    s_add_u32 s77, s77, s78
    s_waitcnt lgkmcnt(0)
    s_barrier
    v_mfma_f32_16x16x32_bf16 v[0:3], v[128:131], v[108:111], v[0:3]
    v_add_u32 v144, s78, v144
    v_add_u32 v148, s78, v148
    v_mfma_f32_16x16x32_bf16 v[16:19], v[128:131], v[112:115], v[16:19]
    ds_read_b64_tr_b16 v[92:93], v144 offset:0
    ds_read_b64_tr_b16 v[94:95], v144 offset:3840
    v_mfma_f32_16x16x32_bf16 v[32:35], v[128:131], v[116:119], v[32:35]
    ds_read_b128 v[72:75], v148 offset:0
    ds_read_b128 v[76:79], v148 offset:2048
    v_mfma_f32_16x16x32_bf16 v[48:51], v[128:131], v[120:123], v[48:51]
    ds_read_b128 v[80:83], v148 offset:4096
    ds_read_b128 v[84:87], v148 offset:6144
    v_mfma_f32_16x16x32_bf16 v[4:7], v[132:135], v[108:111], v[4:7]
    v_add_u32 v145, s78, v145
    ds_read_b64_tr_b16 v[96:97], v145 offset:0
    v_mfma_f32_16x16x32_bf16 v[20:23], v[132:135], v[112:115], v[20:23]
    ds_read_b64_tr_b16 v[98:99], v145 offset:3840
    v_add_u32 v146, s78, v146
    v_mfma_f32_16x16x32_bf16 v[36:39], v[132:135], v[116:119], v[36:39]
    ds_read_b64_tr_b16 v[100:101], v146 offset:0
    ds_read_b64_tr_b16 v[102:103], v146 offset:3840
    v_mfma_f32_16x16x32_bf16 v[52:55], v[132:135], v[120:123], v[52:55]
    v_add_u32 v150, s78, v150
    ds_read_b128 v[88:91], v150
    v_mfma_f32_16x16x32_bf16 v[8:11], v[136:139], v[108:111], v[8:11]
    v_add_u32 v149, s78, v149
    v_add_u32 v151, s78, v151
    v_mfma_f32_16x16x32_bf16 v[24:27], v[136:139], v[112:115], v[24:27]
    v_mfma_f32_16x16x32_bf16 v[40:43], v[136:139], v[116:119], v[40:43]
    v_mfma_f32_16x16x32_bf16 v[56:59], v[136:139], v[120:123], v[56:59]
    v_mfma_f32_16x16x32_bf16 v[64:67], v[128:131], v[124:127], v[64:67]
    v_mfma_f32_16x16x32_bf16 v[68:71], v[132:135], v[124:127], v[68:71]
    s_add_u32 s76, s76, 1
    s_cmp_eq_u32 s76, 9
    s_cbranch_scc0 gated_mix__sliding_local_dilated__dense_activation_mish__prompt_kernel_c3a_loop_ng
    s_nop 7
    s_call_b64 s[88:89], gated_mix__sliding_local_dilated__dense_activation_mish__prompt_kernel_auxg
gated_mix__sliding_local_dilated__dense_activation_mish__prompt_kernel_c3a_loop_ng:
    s_cmp_lt_u32 s76, 10
    s_cbranch_scc1 gated_mix__sliding_local_dilated__dense_activation_mish__prompt_kernel_c3a_loop
    s_waitcnt lgkmcnt(0)
    s_setprio 2
    v_and_b32 v154, 15, v153
    v_lshrrev_b32 v155, 4, v153
    v_mul_u32_u24 v154, 488, v154
    v_lshl_add_u32 v154, v155, 3, v154
    s_lshl_b32 s60, s59, 5
    v_add_u32 v154, s60, v154
    s_lshl_b32 s60, s57, 2
    s_add_u32 s60, s60, 1
    s_mul_i32 s60, s60, 7808
    v_add_u32 v155, s60, v154
    v_cvt_pk_bf16_f32 v72, v0, v1
    v_cvt_pk_bf16_f32 v73, v2, v3
    ds_write_b64 v155, v[72:73] offset:0
    v_cvt_pk_bf16_f32 v74, v16, v17
    v_cvt_pk_bf16_f32 v75, v18, v19
    ds_write_b64 v155, v[74:75] offset:7808
    v_cvt_pk_bf16_f32 v76, v32, v33
    v_cvt_pk_bf16_f32 v77, v34, v35
    ds_write_b64 v155, v[76:77] offset:15616
    v_cvt_pk_bf16_f32 v78, v48, v49
    v_cvt_pk_bf16_f32 v79, v50, v51
    ds_write_b64 v155, v[78:79] offset:23424
    v_cvt_pk_bf16_f32 v80, v4, v5
    v_cvt_pk_bf16_f32 v81, v6, v7
    ds_write_b64 v155, v[80:81] offset:32
    v_cvt_pk_bf16_f32 v82, v20, v21
    v_cvt_pk_bf16_f32 v83, v22, v23
    ds_write_b64 v155, v[82:83] offset:7840
    v_cvt_pk_bf16_f32 v84, v36, v37
    v_cvt_pk_bf16_f32 v85, v38, v39
    ds_write_b64 v155, v[84:85] offset:15648
    v_cvt_pk_bf16_f32 v86, v52, v53
    v_cvt_pk_bf16_f32 v87, v54, v55
    ds_write_b64 v155, v[86:87] offset:23456
    v_cvt_pk_bf16_f32 v88, v8, v9
    v_cvt_pk_bf16_f32 v89, v10, v11
    ds_write_b64 v155, v[88:89] offset:64
    v_cvt_pk_bf16_f32 v90, v24, v25
    v_cvt_pk_bf16_f32 v91, v26, v27
    ds_write_b64 v155, v[90:91] offset:7872
    v_cvt_pk_bf16_f32 v92, v40, v41
    v_cvt_pk_bf16_f32 v93, v42, v43
    ds_write_b64 v155, v[92:93] offset:15680
    v_cvt_pk_bf16_f32 v94, v56, v57
    v_cvt_pk_bf16_f32 v95, v58, v59
    ds_write_b64 v155, v[94:95] offset:23488
    v_cvt_pk_bf16_f32 v96, v64, v65
    v_cvt_pk_bf16_f32 v97, v66, v67
    ds_write_b64 v154, v[96:97] offset:0
    v_cvt_pk_bf16_f32 v98, v68, v69
    v_cvt_pk_bf16_f32 v99, v70, v71
    ds_write_b64 v154, v[98:99] offset:32
    s_branch gated_mix__sliding_local_dilated__dense_activation_mish__prompt_kernel_attn
gated_mix__sliding_local_dilated__dense_activation_mish__prompt_kernel_c3b:
    s_barrier
    ds_read_b64_tr_b16 v[92:93], v144 offset:0
    ds_read_b64_tr_b16 v[94:95], v144 offset:3840
    ds_read_b128 v[72:75], v148 offset:0
    ds_read_b128 v[76:79], v148 offset:2048
    ds_read_b128 v[80:83], v148 offset:4096
    ds_read_b128 v[84:87], v148 offset:6144
    ds_read_b64_tr_b16 v[96:97], v145 offset:0
    ds_read_b64_tr_b16 v[98:99], v145 offset:3840
    ds_read_b64_tr_b16 v[100:101], v146 offset:0
    ds_read_b64_tr_b16 v[102:103], v146 offset:3840
    ds_read_b128 v[88:91], v150
gated_mix__sliding_local_dilated__dense_activation_mish__prompt_kernel_c3b_loop:
    s_waitcnt lgkmcnt(0)
    v_mfma_f32_16x16x32_bf16 v[0:3], v[92:95], v[72:75], v[0:3]
    ds_read_b64_tr_b16 v[128:129], v144 offset:15360
    v_mfma_f32_16x16x32_bf16 v[16:19], v[92:95], v[76:79], v[16:19]
    ds_read_b64_tr_b16 v[130:131], v144 offset:19200
    v_mfma_f32_16x16x32_bf16 v[32:35], v[92:95], v[80:83], v[32:35]
    ds_read_b128 v[108:111], v149 offset:0
    v_mfma_f32_16x16x32_bf16 v[48:51], v[92:95], v[84:87], v[48:51]
    ds_read_b128 v[112:115], v149 offset:2048
    v_mfma_f32_16x16x32_bf16 v[4:7], v[96:99], v[72:75], v[4:7]
    ds_read_b128 v[116:119], v149 offset:4096
    v_mfma_f32_16x16x32_bf16 v[20:23], v[96:99], v[76:79], v[20:23]
    ds_read_b128 v[120:123], v149 offset:6144
    v_mfma_f32_16x16x32_bf16 v[36:39], v[96:99], v[80:83], v[36:39]
    ds_read_b64_tr_b16 v[132:133], v145 offset:15360
    v_mfma_f32_16x16x32_bf16 v[52:55], v[96:99], v[84:87], v[52:55]
    ds_read_b64_tr_b16 v[134:135], v145 offset:19200
    v_mfma_f32_16x16x32_bf16 v[8:11], v[100:103], v[72:75], v[8:11]
    ds_read_b64_tr_b16 v[136:137], v146 offset:15360
    v_mfma_f32_16x16x32_bf16 v[24:27], v[100:103], v[76:79], v[24:27]
    ds_read_b64_tr_b16 v[138:139], v146 offset:19200
    v_mfma_f32_16x16x32_bf16 v[40:43], v[100:103], v[80:83], v[40:43]
    ds_read_b128 v[124:127], v151
    v_mfma_f32_16x16x32_bf16 v[56:59], v[100:103], v[84:87], v[56:59]
    v_mfma_f32_16x16x32_bf16 v[64:67], v[100:103], v[88:91], v[64:67]
    s_cmp_eq_u32 s77, 98304
    s_cselect_b32 s78, 4294868992, s49
    s_add_u32 s77, s77, s78
    s_waitcnt lgkmcnt(0)
    s_barrier
    v_mfma_f32_16x16x32_bf16 v[0:3], v[128:131], v[108:111], v[0:3]
    v_add_u32 v144, s78, v144
    v_add_u32 v148, s78, v148
    v_mfma_f32_16x16x32_bf16 v[16:19], v[128:131], v[112:115], v[16:19]
    ds_read_b64_tr_b16 v[92:93], v144 offset:0
    ds_read_b64_tr_b16 v[94:95], v144 offset:3840
    v_mfma_f32_16x16x32_bf16 v[32:35], v[128:131], v[116:119], v[32:35]
    ds_read_b128 v[72:75], v148 offset:0
    ds_read_b128 v[76:79], v148 offset:2048
    v_mfma_f32_16x16x32_bf16 v[48:51], v[128:131], v[120:123], v[48:51]
    ds_read_b128 v[80:83], v148 offset:4096
    ds_read_b128 v[84:87], v148 offset:6144
    v_mfma_f32_16x16x32_bf16 v[4:7], v[132:135], v[108:111], v[4:7]
    v_add_u32 v145, s78, v145
    ds_read_b64_tr_b16 v[96:97], v145 offset:0
    v_mfma_f32_16x16x32_bf16 v[20:23], v[132:135], v[112:115], v[20:23]
    ds_read_b64_tr_b16 v[98:99], v145 offset:3840
    v_add_u32 v146, s78, v146
    v_mfma_f32_16x16x32_bf16 v[36:39], v[132:135], v[116:119], v[36:39]
    ds_read_b64_tr_b16 v[100:101], v146 offset:0
    ds_read_b64_tr_b16 v[102:103], v146 offset:3840
    v_mfma_f32_16x16x32_bf16 v[52:55], v[132:135], v[120:123], v[52:55]
    v_add_u32 v150, s78, v150
    ds_read_b128 v[88:91], v150
    v_mfma_f32_16x16x32_bf16 v[8:11], v[136:139], v[108:111], v[8:11]
    v_add_u32 v149, s78, v149
    v_add_u32 v151, s78, v151
    v_mfma_f32_16x16x32_bf16 v[24:27], v[136:139], v[112:115], v[24:27]
    v_mfma_f32_16x16x32_bf16 v[40:43], v[136:139], v[116:119], v[40:43]
    v_mfma_f32_16x16x32_bf16 v[56:59], v[136:139], v[120:123], v[56:59]
    v_mfma_f32_16x16x32_bf16 v[64:67], v[136:139], v[124:127], v[64:67]
    s_add_u32 s76, s76, 1
    s_cmp_eq_u32 s76, 9
    s_cbranch_scc0 gated_mix__sliding_local_dilated__dense_activation_mish__prompt_kernel_c3b_loop_ng
    s_nop 7
    s_call_b64 s[88:89], gated_mix__sliding_local_dilated__dense_activation_mish__prompt_kernel_auxg
gated_mix__sliding_local_dilated__dense_activation_mish__prompt_kernel_c3b_loop_ng:
    s_cmp_lt_u32 s76, 10
    s_cbranch_scc1 gated_mix__sliding_local_dilated__dense_activation_mish__prompt_kernel_c3b_loop
    s_waitcnt lgkmcnt(0)
    s_setprio 2
    v_and_b32 v154, 15, v153
    v_lshrrev_b32 v155, 4, v153
    v_mul_u32_u24 v154, 488, v154
    v_lshl_add_u32 v154, v155, 3, v154
    s_lshl_b32 s60, s59, 5
    v_add_u32 v154, s60, v154
    s_lshl_b32 s60, s57, 2
    s_add_u32 s60, s60, 1
    s_mul_i32 s60, s60, 7808
    v_add_u32 v155, s60, v154
    v_cvt_pk_bf16_f32 v72, v0, v1
    v_cvt_pk_bf16_f32 v73, v2, v3
    ds_write_b64 v155, v[72:73] offset:0
    v_cvt_pk_bf16_f32 v74, v16, v17
    v_cvt_pk_bf16_f32 v75, v18, v19
    ds_write_b64 v155, v[74:75] offset:7808
    v_cvt_pk_bf16_f32 v76, v32, v33
    v_cvt_pk_bf16_f32 v77, v34, v35
    ds_write_b64 v155, v[76:77] offset:15616
    v_cvt_pk_bf16_f32 v78, v48, v49
    v_cvt_pk_bf16_f32 v79, v50, v51
    ds_write_b64 v155, v[78:79] offset:23424
    v_cvt_pk_bf16_f32 v80, v4, v5
    v_cvt_pk_bf16_f32 v81, v6, v7
    ds_write_b64 v155, v[80:81] offset:32
    v_cvt_pk_bf16_f32 v82, v20, v21
    v_cvt_pk_bf16_f32 v83, v22, v23
    ds_write_b64 v155, v[82:83] offset:7840
    v_cvt_pk_bf16_f32 v84, v36, v37
    v_cvt_pk_bf16_f32 v85, v38, v39
    ds_write_b64 v155, v[84:85] offset:15648
    v_cvt_pk_bf16_f32 v86, v52, v53
    v_cvt_pk_bf16_f32 v87, v54, v55
    ds_write_b64 v155, v[86:87] offset:23456
    v_cvt_pk_bf16_f32 v88, v8, v9
    v_cvt_pk_bf16_f32 v89, v10, v11
    ds_write_b64 v155, v[88:89] offset:64
    v_cvt_pk_bf16_f32 v90, v24, v25
    v_cvt_pk_bf16_f32 v91, v26, v27
    ds_write_b64 v155, v[90:91] offset:7872
    v_cvt_pk_bf16_f32 v92, v40, v41
    v_cvt_pk_bf16_f32 v93, v42, v43
    ds_write_b64 v155, v[92:93] offset:15680
    v_cvt_pk_bf16_f32 v94, v56, v57
    v_cvt_pk_bf16_f32 v95, v58, v59
    ds_write_b64 v155, v[94:95] offset:23488
    v_cvt_pk_bf16_f32 v96, v64, v65
    v_cvt_pk_bf16_f32 v97, v66, v67
    ds_write_b64 v154, v[96:97] offset:64
    s_branch gated_mix__sliding_local_dilated__dense_activation_mish__prompt_kernel_attn
gated_mix__sliding_local_dilated__dense_activation_mish__prompt_kernel_c3:
    s_barrier
    ds_read_b64_tr_b16 v[92:93], v144 offset:0
    ds_read_b64_tr_b16 v[94:95], v144 offset:3840
    ds_read_b128 v[72:75], v148 offset:0
    ds_read_b128 v[76:79], v148 offset:2048
    ds_read_b128 v[80:83], v148 offset:4096
    ds_read_b128 v[84:87], v148 offset:6144
    ds_read_b64_tr_b16 v[96:97], v145 offset:0
    ds_read_b64_tr_b16 v[98:99], v145 offset:3840
gated_mix__sliding_local_dilated__dense_activation_mish__prompt_kernel_c3_loop:
    s_waitcnt lgkmcnt(0)
    v_mfma_f32_16x16x32_bf16 v[0:3], v[92:95], v[72:75], v[0:3]
    ds_read_b64_tr_b16 v[128:129], v144 offset:15360
    v_mfma_f32_16x16x32_bf16 v[16:19], v[92:95], v[76:79], v[16:19]
    ds_read_b64_tr_b16 v[130:131], v144 offset:19200
    v_mfma_f32_16x16x32_bf16 v[32:35], v[92:95], v[80:83], v[32:35]
    ds_read_b128 v[108:111], v149 offset:0
    v_mfma_f32_16x16x32_bf16 v[48:51], v[92:95], v[84:87], v[48:51]
    ds_read_b128 v[112:115], v149 offset:2048
    v_mfma_f32_16x16x32_bf16 v[4:7], v[96:99], v[72:75], v[4:7]
    ds_read_b128 v[116:119], v149 offset:4096
    v_mfma_f32_16x16x32_bf16 v[20:23], v[96:99], v[76:79], v[20:23]
    ds_read_b128 v[120:123], v149 offset:6144
    v_mfma_f32_16x16x32_bf16 v[36:39], v[96:99], v[80:83], v[36:39]
    ds_read_b64_tr_b16 v[132:133], v145 offset:15360
    v_mfma_f32_16x16x32_bf16 v[52:55], v[96:99], v[84:87], v[52:55]
    ds_read_b64_tr_b16 v[134:135], v145 offset:19200
    s_cmp_eq_u32 s77, 98304
    s_cselect_b32 s78, 4294868992, s49
    s_add_u32 s77, s77, s78
    s_waitcnt lgkmcnt(0)
    s_barrier
    v_mfma_f32_16x16x32_bf16 v[0:3], v[128:131], v[108:111], v[0:3]
    v_add_u32 v144, s78, v144
    v_add_u32 v148, s78, v148
    v_mfma_f32_16x16x32_bf16 v[16:19], v[128:131], v[112:115], v[16:19]
    ds_read_b64_tr_b16 v[92:93], v144 offset:0
    ds_read_b64_tr_b16 v[94:95], v144 offset:3840
    v_mfma_f32_16x16x32_bf16 v[32:35], v[128:131], v[116:119], v[32:35]
    ds_read_b128 v[72:75], v148 offset:0
    ds_read_b128 v[76:79], v148 offset:2048
    v_mfma_f32_16x16x32_bf16 v[48:51], v[128:131], v[120:123], v[48:51]
    ds_read_b128 v[80:83], v148 offset:4096
    ds_read_b128 v[84:87], v148 offset:6144
    v_mfma_f32_16x16x32_bf16 v[4:7], v[132:135], v[108:111], v[4:7]
    v_add_u32 v145, s78, v145
    ds_read_b64_tr_b16 v[96:97], v145 offset:0
    v_mfma_f32_16x16x32_bf16 v[20:23], v[132:135], v[112:115], v[20:23]
    ds_read_b64_tr_b16 v[98:99], v145 offset:3840
    v_mfma_f32_16x16x32_bf16 v[36:39], v[132:135], v[116:119], v[36:39]
    v_add_u32 v149, s78, v149
    v_mfma_f32_16x16x32_bf16 v[52:55], v[132:135], v[120:123], v[52:55]
    s_add_u32 s76, s76, 1
    s_cmp_eq_u32 s76, 9
    s_cbranch_scc0 gated_mix__sliding_local_dilated__dense_activation_mish__prompt_kernel_c3_loop_ng
    s_nop 7
    s_call_b64 s[88:89], gated_mix__sliding_local_dilated__dense_activation_mish__prompt_kernel_auxg
gated_mix__sliding_local_dilated__dense_activation_mish__prompt_kernel_c3_loop_ng:
    s_cmp_lt_u32 s76, 10
    s_cbranch_scc1 gated_mix__sliding_local_dilated__dense_activation_mish__prompt_kernel_c3_loop
    s_waitcnt lgkmcnt(0)
    s_setprio 2
    s_branch gated_mix__sliding_local_dilated__dense_activation_mish__prompt_kernel_epiB3
gated_mix__sliding_local_dilated__dense_activation_mish__prompt_kernel_attn:
    v_and_b32 v154, 15, v153
    v_lshrrev_b32 v155, 4, v153
    s_mul_i32 s60, s50, 7808
    v_mul_u32_u24 v157, 488, v154
    v_lshl_add_u32 v157, v155, 4, v157
    v_add_u32 v157, s60, v157
    v_add_u32 v156, 7808, v157
    v_add_u32 v157, 160, v157
    v_add_u32 v158, 160, v156
    v_lshrrev_b32 v163, 2, v154
    v_lshl_add_u32 v163, v155, 2, v163
    v_mul_u32_u24 v159, 488, v163
    v_and_b32 v163, 3, v154
    v_lshl_add_u32 v159, v163, 3, v159
    v_add_u32 v159, s60, v159
    v_add_u32 v159, 320, v159
    v_cmp_gt_u32 vcc, 3, v155
    s_nop 1
    v_cndmask_b32 v160, 0, -1, vcc
    v_cmp_gt_u32 vcc, 2, v155
    s_nop 1
    v_cndmask_b32 v161, 0, -1, vcc
    v_and_b32 v163, 1, v154
    v_lshlrev_b32 v162, 4, v163
    v_cmp_eq_u32 s[60:61], 1, v163
    v_lshrrev_b32 v163, 1, v154
    v_lshlrev_b32 v164, 1, v155
    v_cmp_le_u32 s[62:63], v164, v163
    v_add_u32 v164, 1, v164
    v_cmp_le_u32 s[64:65], v164, v163
    v_cmp_le_u32 s[70:71], 1, v155
    v_cmp_le_u32 s[72:73], 2, v155
    v_cmp_le_u32 s[74:75], 3, v155
    s_add_u32 s76, s52, s50
    s_not_b64 s[66:67], s[62:63]
    s_not_b64 s[68:69], s[64:65]
    s_cmp_eq_u32 s76, 0
    s_cselect_b64 s[66:67], s[66:67], 0
    s_cselect_b64 s[68:69], s[68:69], 0
    s_waitcnt lgkmcnt(0)
    s_barrier
    ds_read2_b64 v[0:3], v156 offset0:0 offset1:1
    ds_read2_b64 v[16:19], v157 offset0:0 offset1:1
    ds_read2_b64 v[32:35], v158 offset0:0 offset1:1
    ds_read2_b64 v[4:7], v156 offset0:5 offset1:6
    ds_read2_b64 v[20:23], v157 offset0:5 offset1:6
    ds_read2_b64 v[36:39], v158 offset0:5 offset1:6
    ds_read2_b64 v[8:11], v156 offset0:10 offset1:11
    ds_read2_b64 v[24:27], v157 offset0:10 offset1:11
    ds_read2_b64 v[40:43], v158 offset0:10 offset1:11
    ds_read2_b64 v[12:15], v156 offset0:15 offset1:16
    ds_read2_b64 v[28:31], v157 offset0:15 offset1:16
    ds_read2_b64 v[44:47], v158 offset0:15 offset1:16
    s_waitcnt lgkmcnt(9)
    v_and_b32 v0, v0, v160
    v_and_b32 v1, v1, v160
    v_and_b32 v2, v2, v161
    v_and_b32 v3, v3, v161
    s_nop 1
    v_mfma_f32_16x16x32_bf16 v[68:71], v[16:19], v[0:3], 0
    v_mfma_f32_16x16x32_bf16 v[84:87], v[32:35], v[0:3], 0
    s_waitcnt lgkmcnt(6)
    v_and_b32 v4, v4, v160
    v_and_b32 v5, v5, v160
    v_and_b32 v6, v6, v161
    v_and_b32 v7, v7, v161
    s_nop 1
    v_mfma_f32_16x16x32_bf16 v[72:75], v[20:23], v[4:7], 0
    v_mfma_f32_16x16x32_bf16 v[88:91], v[36:39], v[4:7], 0
    s_waitcnt lgkmcnt(3)
    v_and_b32 v8, v8, v160
    v_and_b32 v9, v9, v160
    v_and_b32 v10, v10, v161
    v_and_b32 v11, v11, v161
    s_nop 1
    v_mfma_f32_16x16x32_bf16 v[76:79], v[24:27], v[8:11], 0
    v_mfma_f32_16x16x32_bf16 v[92:95], v[40:43], v[8:11], 0
    s_waitcnt lgkmcnt(0)
    v_and_b32 v12, v12, v160
    v_and_b32 v13, v13, v160
    v_and_b32 v14, v14, v161
    v_and_b32 v15, v15, v161
    s_nop 1
    v_mfma_f32_16x16x32_bf16 v[80:83], v[28:31], v[12:15], 0
    v_mfma_f32_16x16x32_bf16 v[96:99], v[44:47], v[12:15], 0
    ds_read_b64_tr_b16 v[48:49], v159 offset:0
    ds_read_b64_tr_b16 v[50:51], v159 offset:7808
    ds_read_b64_tr_b16 v[52:53], v159 offset:32
    ds_read_b64_tr_b16 v[54:55], v159 offset:7840
    ds_read_b64_tr_b16 v[56:57], v159 offset:64
    ds_read_b64_tr_b16 v[58:59], v159 offset:7872
    ds_read_b64_tr_b16 v[60:61], v159 offset:96
    ds_read_b64_tr_b16 v[62:63], v159 offset:7904
    ds_read_b64_tr_b16 v[64:65], v159 offset:128
    ds_read_b64_tr_b16 v[66:67], v159 offset:7936
    s_mov_b32 s77, 0xffff0000
    s_mov_b32 s78, 1046804782
    s_mov_b32 s79, 0xce6e6b28
    v_mov_b32 v165, s79
    v_cndmask_b32 v68, v68, v69, s[60:61]
    v_cndmask_b32 v84, v84, v85, s[60:61]
    v_cndmask_b32 v70, v70, v71, s[60:61]
    v_cndmask_b32 v86, v86, v87, s[60:61]
    v_cndmask_b32 v72, v72, v73, s[60:61]
    v_cndmask_b32 v88, v88, v89, s[60:61]
    v_cndmask_b32 v74, v74, v75, s[60:61]
    v_cndmask_b32 v90, v90, v91, s[60:61]
    v_cndmask_b32 v76, v76, v77, s[60:61]
    v_cndmask_b32 v92, v92, v93, s[60:61]
    v_cndmask_b32 v78, v78, v79, s[60:61]
    v_cndmask_b32 v94, v94, v95, s[60:61]
    v_cndmask_b32 v80, v80, v81, s[60:61]
    v_cndmask_b32 v96, v96, v97, s[60:61]
    v_cndmask_b32 v82, v82, v83, s[60:61]
    v_cndmask_b32 v98, v98, v99, s[60:61]
    v_cndmask_b32 v100, v68, v84, s[62:63]
    v_cndmask_b32 v101, v70, v86, s[64:65]
    v_cndmask_b32 v102, v72, v88, s[62:63]
    v_cndmask_b32 v103, v74, v90, s[64:65]
    v_cndmask_b32 v104, v76, v92, s[62:63]
    v_cndmask_b32 v105, v78, v94, s[64:65]
    v_cndmask_b32 v106, v80, v96, s[62:63]
    v_cndmask_b32 v107, v82, v98, s[64:65]
    v_cvt_pk_bf16_f32 v112, v100, v101
    v_lshlrev_b32 v100, 16, v112
    v_and_b32 v101, s77, v112
    v_mul_f32 v100, s78, v100
    v_mul_f32 v101, s78, v101
    v_cvt_pk_bf16_f32 v112, v100, v101
    v_lshlrev_b32 v100, 16, v112
    v_and_b32 v101, s77, v112
    v_cndmask_b32 v100, v100, v165, s[66:67]
    v_cndmask_b32 v101, v101, v165, s[68:69]
    v_max_f32 v108, v100, v101
    v_cvt_pk_bf16_f32 v113, v102, v103
    v_lshlrev_b32 v102, 16, v113
    v_and_b32 v103, s77, v113
    v_mul_f32 v102, s78, v102
    v_mul_f32 v103, s78, v103
    v_cvt_pk_bf16_f32 v113, v102, v103
    v_lshlrev_b32 v102, 16, v113
    v_and_b32 v103, s77, v113
    v_cndmask_b32 v102, v102, v165, s[66:67]
    v_cndmask_b32 v103, v103, v165, s[68:69]
    v_max_f32 v109, v102, v103
    v_cvt_pk_bf16_f32 v114, v104, v105
    v_lshlrev_b32 v104, 16, v114
    v_and_b32 v105, s77, v114
    v_mul_f32 v104, s78, v104
    v_mul_f32 v105, s78, v105
    v_cvt_pk_bf16_f32 v114, v104, v105
    v_lshlrev_b32 v104, 16, v114
    v_and_b32 v105, s77, v114
    v_cndmask_b32 v104, v104, v165, s[66:67]
    v_cndmask_b32 v105, v105, v165, s[68:69]
    v_max_f32 v110, v104, v105
    v_cvt_pk_bf16_f32 v115, v106, v107
    v_lshlrev_b32 v106, 16, v115
    v_and_b32 v107, s77, v115
    v_mul_f32 v106, s78, v106
    v_mul_f32 v107, s78, v107
    v_cvt_pk_bf16_f32 v115, v106, v107
    v_lshlrev_b32 v106, 16, v115
    v_and_b32 v107, s77, v115
    v_cndmask_b32 v106, v106, v165, s[66:67]
    v_cndmask_b32 v107, v107, v165, s[68:69]
    v_max_f32 v111, v106, v107
    v_mov_b32 v112, v108
    v_mov_b32 v113, v109
    v_mov_b32 v114, v110
    v_mov_b32 v115, v111
    v_permlane16_swap_b32 v112, v108
    v_permlane16_swap_b32 v113, v109
    v_permlane16_swap_b32 v114, v110
    v_permlane16_swap_b32 v115, v111
    v_max_f32 v108, v108, v112
    v_max_f32 v109, v109, v113
    v_max_f32 v110, v110, v114
    v_max_f32 v111, v111, v115
    v_mov_b32 v112, v108
    v_mov_b32 v113, v109
    v_mov_b32 v114, v110
    v_mov_b32 v115, v111
    v_permlane32_swap_b32 v112, v108
    v_permlane32_swap_b32 v113, v109
    v_permlane32_swap_b32 v114, v110
    v_permlane32_swap_b32 v115, v111
    v_max_f32 v108, v108, v112
    v_max_f32 v109, v109, v113
    v_max_f32 v110, v110, v114
    v_max_f32 v111, v111, v115
    s_mov_b32 s79, 1069066811
    v_sub_f32 v100, v100, v108
    v_sub_f32 v101, v101, v108
    v_sub_f32 v102, v102, v109
    v_sub_f32 v103, v103, v109
    v_sub_f32 v104, v104, v110
    v_sub_f32 v105, v105, v110
    v_sub_f32 v106, v106, v111
    v_sub_f32 v107, v107, v111
    v_mul_f32 v100, s79, v100
    v_mul_f32 v101, s79, v101
    v_mul_f32 v102, s79, v102
    v_mul_f32 v103, s79, v103
    v_mul_f32 v104, s79, v104
    v_mul_f32 v105, s79, v105
    v_mul_f32 v106, s79, v106
    v_mul_f32 v107, s79, v107
    v_exp_f32 v100, v100
    v_exp_f32 v101, v101
    v_exp_f32 v102, v102
    v_exp_f32 v103, v103
    v_exp_f32 v104, v104
    v_exp_f32 v105, v105
    v_exp_f32 v106, v106
    v_exp_f32 v107, v107
    v_add_f32 v108, v100, v101
    v_add_f32 v109, v102, v103
    v_add_f32 v110, v104, v105
    v_add_f32 v111, v106, v107
    v_mov_b32 v112, v108
    v_mov_b32 v113, v109
    v_mov_b32 v114, v110
    v_mov_b32 v115, v111
    v_permlane16_swap_b32 v112, v108
    v_permlane16_swap_b32 v113, v109
    v_permlane16_swap_b32 v114, v110
    v_permlane16_swap_b32 v115, v111
    v_add_f32 v108, v108, v112
    v_add_f32 v109, v109, v113
    v_add_f32 v110, v110, v114
    v_add_f32 v111, v111, v115
    v_mov_b32 v112, v108
    v_mov_b32 v113, v109
    v_mov_b32 v114, v110
    v_mov_b32 v115, v111
    v_permlane32_swap_b32 v112, v108
    v_permlane32_swap_b32 v113, v109
    v_permlane32_swap_b32 v114, v110
    v_permlane32_swap_b32 v115, v111
    v_add_f32 v108, v108, v112
    v_add_f32 v109, v109, v113
    v_add_f32 v110, v110, v114
    v_add_f32 v111, v111, v115
    v_rcp_f32 v108, v108
    v_rcp_f32 v109, v109
    v_rcp_f32 v110, v110
    v_rcp_f32 v111, v111
    v_mul_f32 v100, v100, v108
    v_mul_f32 v101, v101, v108
    v_mul_f32 v102, v102, v109
    v_mul_f32 v103, v103, v109
    v_mul_f32 v104, v104, v110
    v_mul_f32 v105, v105, v110
    v_mul_f32 v106, v106, v111
    v_mul_f32 v107, v107, v111
    v_cvt_pk_bf16_f32 v100, v100, 0
    v_cvt_pk_bf16_f32 v101, v101, 0
    v_cvt_pk_bf16_f32 v102, v102, 0
    v_cvt_pk_bf16_f32 v103, v103, 0
    v_cvt_pk_bf16_f32 v104, v104, 0
    v_cvt_pk_bf16_f32 v105, v105, 0
    v_cvt_pk_bf16_f32 v106, v106, 0
    v_cvt_pk_bf16_f32 v107, v107, 0
    v_lshlrev_b32 v100, v162, v100
    v_lshlrev_b32 v101, v162, v101
    v_lshlrev_b32 v102, v162, v102
    v_lshlrev_b32 v103, v162, v103
    v_lshlrev_b32 v104, v162, v104
    v_lshlrev_b32 v105, v162, v105
    v_lshlrev_b32 v106, v162, v106
    v_lshlrev_b32 v107, v162, v107
    v_cndmask_b32 v116, v100, 0, s[62:63]
    v_cndmask_b32 v118, 0, v100, s[62:63]
    v_cndmask_b32 v117, v101, 0, s[64:65]
    v_cndmask_b32 v119, 0, v101, s[64:65]
    v_cndmask_b32 v120, v102, 0, s[62:63]
    v_cndmask_b32 v122, 0, v102, s[62:63]
    v_cndmask_b32 v121, v103, 0, s[64:65]
    v_cndmask_b32 v123, 0, v103, s[64:65]
    v_cndmask_b32 v124, v104, 0, s[62:63]
    v_cndmask_b32 v126, 0, v104, s[62:63]
    v_cndmask_b32 v125, v105, 0, s[64:65]
    v_cndmask_b32 v127, 0, v105, s[64:65]
    v_cndmask_b32 v128, v106, 0, s[62:63]
    v_cndmask_b32 v130, 0, v106, s[62:63]
    v_cndmask_b32 v129, v107, 0, s[64:65]
    v_cndmask_b32 v131, 0, v107, s[64:65]
    s_waitcnt lgkmcnt(0)
    v_mfma_f32_16x16x32_bf16 v[0:3], v[48:51], v[116:119], 0
    v_mfma_f32_16x16x32_bf16 v[4:7], v[52:55], v[116:119], 0
    v_mfma_f32_16x16x32_bf16 v[8:11], v[52:55], v[120:123], 0
    v_mfma_f32_16x16x32_bf16 v[12:15], v[56:59], v[120:123], 0
    v_mfma_f32_16x16x32_bf16 v[16:19], v[56:59], v[124:127], 0
    v_mfma_f32_16x16x32_bf16 v[20:23], v[60:63], v[124:127], 0
    v_mfma_f32_16x16x32_bf16 v[24:27], v[60:63], v[128:131], 0
    v_mfma_f32_16x16x32_bf16 v[28:31], v[64:67], v[128:131], 0
    s_lshr_b32 s60, s50, 2
    s_lshl_b32 s61, s54, 1
    s_add_u32 s60, s60, s61
    s_mul_i32 s60, s60, 74
    s_mul_i32 s61, s53, 5
    s_lshr_b32 s61, s61, 1
    s_add_u32 s60, s60, s61
    s_lshl_b32 s60, s60, 2
    s_and_b32 s61, s50, 3
    s_add_u32 s60, s60, s61
    s_lshl_b32 s60, s60, 10
    s_add_u32 s61, s60, 4096
    s_add_u32 s62, s60, 8192
    v_cvt_pk_bf16_f32 v132, v0, v1
    v_cvt_pk_bf16_f32 v133, v2, v3
    v_cndmask_b32 v4, v4, v8, s[70:71]
    v_cndmask_b32 v5, v5, v9, s[70:71]
    v_cndmask_b32 v6, v6, v10, s[70:71]
    v_cndmask_b32 v7, v7, v11, s[70:71]
    v_cvt_pk_bf16_f32 v134, v4, v5
    v_cvt_pk_bf16_f32 v135, v6, v7
    v_cndmask_b32 v12, v12, v16, s[72:73]
    v_cndmask_b32 v13, v13, v17, s[72:73]
    v_cndmask_b32 v14, v14, v18, s[72:73]
    v_cndmask_b32 v15, v15, v19, s[72:73]
    v_cvt_pk_bf16_f32 v136, v12, v13
    v_cvt_pk_bf16_f32 v137, v14, v15
    v_cndmask_b32 v20, v20, v24, s[74:75]
    v_cndmask_b32 v21, v21, v25, s[74:75]
    v_cndmask_b32 v22, v22, v26, s[74:75]
    v_cndmask_b32 v23, v23, v27, s[74:75]
    v_cvt_pk_bf16_f32 v138, v20, v21
    v_cvt_pk_bf16_f32 v139, v22, v23
    v_cvt_pk_bf16_f32 v140, v28, v29
    v_cvt_pk_bf16_f32 v141, v30, v31
    v_lshlrev_b32 v154, 3, v153
    s_and_b32 s63, s53, 1
    s_cmp_eq_u32 s63, 1
    s_cbranch_scc1 gated_mix__sliding_local_dilated__dense_activation_mish__prompt_kernel_ostodd
    buffer_store_dwordx4 v[132:135], v152, s[28:31], s60 offen sc1
    buffer_store_dwordx4 v[136:139], v152, s[28:31], s61 offen sc1
    buffer_store_dwordx2 v[140:141], v154, s[28:31], s62 offen sc1
    s_branch gated_mix__sliding_local_dilated__dense_activation_mish__prompt_kernel_done
gated_mix__sliding_local_dilated__dense_activation_mish__prompt_kernel_ostodd:
    buffer_store_dwordx2 v[132:133], v154, s[28:31], s60 offen offset:512 sc1
    buffer_store_dwordx4 v[134:137], v152, s[28:31], s61 offen sc1
    buffer_store_dwordx4 v[138:141], v152, s[28:31], s62 offen sc1
    s_branch gated_mix__sliding_local_dilated__dense_activation_mish__prompt_kernel_done
gated_mix__sliding_local_dilated__dense_activation_mish__prompt_kernel_epiB4:
    s_mov_b32 s77, 0xffff0000
    s_mov_b32 s78, 1069066811
    s_mov_b32 s79, 1069066811
    s_mov_b32 s66, 1.0
    s_mov_b32 s67, 1.0
    v_mov_b32 v164, -2.0
    v_mov_b32 v165, -2.0
    s_add_u32 s60, s55, s59
    s_lshl_b32 s61, s54, 1
    s_add_u32 s61, s61, s57
    s_mul_i32 s61, s61, 74
    s_lshr_b32 s62, s60, 1
    s_add_u32 s61, s61, s62
    s_add_u32 s61, s61, 20
    s_lshl_b32 s61, s61, 12
    s_add_u32 s62, s61, 4096
    v_lshlrev_b32 v72, 16, v154
    v_and_b32 v73, s77, v154
    v_lshlrev_b32 v74, 16, v155
    v_and_b32 v75, s77, v155
    v_lshlrev_b32 v76, 16, v156
    v_and_b32 v77, s77, v156
    v_lshlrev_b32 v78, 16, v157
    v_and_b32 v79, s77, v157
    v_lshlrev_b32 v80, 16, v158
    v_and_b32 v81, s77, v158
    v_lshlrev_b32 v82, 16, v159
    v_and_b32 v83, s77, v159
    v_lshlrev_b32 v84, 16, v160
    v_and_b32 v85, s77, v160
    v_lshlrev_b32 v86, 16, v161
    v_and_b32 v87, s77, v161
    s_mov_b32 s63, 0
gated_mix__sliding_local_dilated__dense_activation_mish__prompt_kernel_ml4:
    s_set_gpr_idx_on s63, gpr_idx(SRC0)
    s_nop 1
    v_pk_add_f32 v[104:105], v[0:1], v[72:73]
    v_pk_add_f32 v[106:107], v[2:3], v[74:75]
    v_pk_add_f32 v[108:109], v[4:5], v[76:77]
    v_pk_add_f32 v[110:111], v[6:7], v[78:79]
    v_pk_add_f32 v[112:113], v[8:9], v[80:81]
    v_pk_add_f32 v[114:115], v[10:11], v[82:83]
    v_pk_add_f32 v[116:117], v[12:13], v[84:85]
    v_pk_add_f32 v[118:119], v[14:15], v[86:87]
    s_set_gpr_idx_off
    s_nop 1
    v_pk_mul_f32 v[88:89], v[104:105], s[78:79]
    v_pk_mul_f32 v[90:91], v[106:107], s[78:79]
    v_pk_mul_f32 v[92:93], v[108:109], s[78:79]
    v_pk_mul_f32 v[94:95], v[110:111], s[78:79]
    v_pk_mul_f32 v[96:97], v[112:113], s[78:79]
    v_pk_mul_f32 v[98:99], v[114:115], s[78:79]
    v_pk_mul_f32 v[100:101], v[116:117], s[78:79]
    v_pk_mul_f32 v[102:103], v[118:119], s[78:79]
    v_exp_f32 v88, v88
    v_exp_f32 v89, v89
    v_exp_f32 v90, v90
    v_exp_f32 v91, v91
    v_exp_f32 v92, v92
    v_exp_f32 v93, v93
    v_exp_f32 v94, v94
    v_exp_f32 v95, v95
    v_exp_f32 v96, v96
    v_exp_f32 v97, v97
    v_exp_f32 v98, v98
    v_exp_f32 v99, v99
    v_exp_f32 v100, v100
    v_exp_f32 v101, v101
    v_exp_f32 v102, v102
    v_exp_f32 v103, v103
    v_pk_add_f32 v[88:89], v[88:89], s[66:67]
    v_pk_add_f32 v[90:91], v[90:91], s[66:67]
    v_pk_add_f32 v[92:93], v[92:93], s[66:67]
    v_pk_add_f32 v[94:95], v[94:95], s[66:67]
    v_pk_add_f32 v[96:97], v[96:97], s[66:67]
    v_pk_add_f32 v[98:99], v[98:99], s[66:67]
    v_pk_add_f32 v[100:101], v[100:101], s[66:67]
    v_pk_add_f32 v[102:103], v[102:103], s[66:67]
    v_pk_fma_f32 v[88:89], v[88:89], v[88:89], s[66:67]
    v_pk_fma_f32 v[90:91], v[90:91], v[90:91], s[66:67]
    v_pk_fma_f32 v[92:93], v[92:93], v[92:93], s[66:67]
    v_pk_fma_f32 v[94:95], v[94:95], v[94:95], s[66:67]
    v_pk_fma_f32 v[96:97], v[96:97], v[96:97], s[66:67]
    v_pk_fma_f32 v[98:99], v[98:99], v[98:99], s[66:67]
    v_pk_fma_f32 v[100:101], v[100:101], v[100:101], s[66:67]
    v_pk_fma_f32 v[102:103], v[102:103], v[102:103], s[66:67]
    v_rcp_f32 v88, v88
    v_rcp_f32 v89, v89
    v_rcp_f32 v90, v90
    v_rcp_f32 v91, v91
    v_rcp_f32 v92, v92
    v_rcp_f32 v93, v93
    v_rcp_f32 v94, v94
    v_rcp_f32 v95, v95
    v_rcp_f32 v96, v96
    v_rcp_f32 v97, v97
    v_rcp_f32 v98, v98
    v_rcp_f32 v99, v99
    v_rcp_f32 v100, v100
    v_rcp_f32 v101, v101
    v_rcp_f32 v102, v102
    v_rcp_f32 v103, v103
    v_pk_fma_f32 v[88:89], v[88:89], v[164:165], s[66:67]
    v_pk_fma_f32 v[90:91], v[90:91], v[164:165], s[66:67]
    v_pk_fma_f32 v[92:93], v[92:93], v[164:165], s[66:67]
    v_pk_fma_f32 v[94:95], v[94:95], v[164:165], s[66:67]
    v_pk_fma_f32 v[96:97], v[96:97], v[164:165], s[66:67]
    v_pk_fma_f32 v[98:99], v[98:99], v[164:165], s[66:67]
    v_pk_fma_f32 v[100:101], v[100:101], v[164:165], s[66:67]
    v_pk_fma_f32 v[102:103], v[102:103], v[164:165], s[66:67]
    v_pk_mul_f32 v[88:89], v[88:89], v[104:105]
    v_pk_mul_f32 v[90:91], v[90:91], v[106:107]
    v_pk_mul_f32 v[92:93], v[92:93], v[108:109]
    v_pk_mul_f32 v[94:95], v[94:95], v[110:111]
    v_pk_mul_f32 v[96:97], v[96:97], v[112:113]
    v_pk_mul_f32 v[98:99], v[98:99], v[114:115]
    v_pk_mul_f32 v[100:101], v[100:101], v[116:117]
    v_pk_mul_f32 v[102:103], v[102:103], v[118:119]
    v_cvt_pk_bf16_f32 v120, v88, v89
    v_cvt_pk_bf16_f32 v121, v90, v91
    v_cvt_pk_bf16_f32 v122, v92, v93
    v_cvt_pk_bf16_f32 v123, v94, v95
    v_cvt_pk_bf16_f32 v124, v96, v97
    v_cvt_pk_bf16_f32 v125, v98, v99
    v_cvt_pk_bf16_f32 v126, v100, v101
    v_cvt_pk_bf16_f32 v127, v102, v103
    buffer_store_dwordx4 v[120:123], v152, s[28:31], s61 offen sc1
    buffer_store_dwordx4 v[124:127], v152, s[28:31], s62 offen sc1
    s_add_u32 s61, s61, 1024
    s_add_u32 s62, s62, 1024
    s_add_u32 s63, s63, 16
    s_cmp_lt_u32 s63, 64
    s_cbranch_scc1 gated_mix__sliding_local_dilated__dense_activation_mish__prompt_kernel_ml4
    s_branch gated_mix__sliding_local_dilated__dense_activation_mish__prompt_kernel_done
gated_mix__sliding_local_dilated__dense_activation_mish__prompt_kernel_epiB3:
    s_mov_b32 s77, 0xffff0000
    s_mov_b32 s78, 1069066811
    s_mov_b32 s79, 1069066811
    s_mov_b32 s66, 1.0
    s_mov_b32 s67, 1.0
    v_mov_b32 v164, -2.0
    v_mov_b32 v165, -2.0
    s_add_u32 s60, s55, s59
    s_lshl_b32 s61, s54, 1
    s_add_u32 s61, s61, s57
    s_mul_i32 s61, s61, 74
    s_lshr_b32 s62, s60, 1
    s_add_u32 s61, s61, s62
    s_add_u32 s61, s61, 20
    s_lshl_b32 s61, s61, 12
    s_add_u32 s62, s61, 4096
    v_lshlrev_b32 v72, 16, v154
    v_and_b32 v73, s77, v154
    v_lshlrev_b32 v74, 16, v155
    v_and_b32 v75, s77, v155
    v_lshlrev_b32 v76, 16, v156
    v_and_b32 v77, s77, v156
    v_lshlrev_b32 v78, 16, v157
    v_and_b32 v79, s77, v157
    v_lshlrev_b32 v80, 16, v158
    v_and_b32 v81, s77, v158
    v_lshlrev_b32 v82, 16, v159
    v_and_b32 v83, s77, v159
    v_lshlrev_b32 v84, 16, v160
    v_and_b32 v85, s77, v160
    v_lshlrev_b32 v86, 16, v161
    v_and_b32 v87, s77, v161
    s_mov_b32 s63, 0
gated_mix__sliding_local_dilated__dense_activation_mish__prompt_kernel_ml2:
    s_set_gpr_idx_on s63, gpr_idx(SRC0)
    s_nop 1
    v_pk_add_f32 v[104:105], v[0:1], v[72:73]
    v_pk_add_f32 v[106:107], v[2:3], v[74:75]
    v_pk_add_f32 v[108:109], v[4:5], v[76:77]
    v_pk_add_f32 v[110:111], v[6:7], v[78:79]
    s_set_gpr_idx_off
    s_nop 1
    v_pk_mul_f32 v[88:89], v[104:105], s[78:79]
    v_pk_mul_f32 v[90:91], v[106:107], s[78:79]
    v_pk_mul_f32 v[92:93], v[108:109], s[78:79]
    v_pk_mul_f32 v[94:95], v[110:111], s[78:79]
    v_exp_f32 v88, v88
    v_exp_f32 v89, v89
    v_exp_f32 v90, v90
    v_exp_f32 v91, v91
    v_exp_f32 v92, v92
    v_exp_f32 v93, v93
    v_exp_f32 v94, v94
    v_exp_f32 v95, v95
    v_pk_add_f32 v[88:89], v[88:89], s[66:67]
    v_pk_add_f32 v[90:91], v[90:91], s[66:67]
    v_pk_add_f32 v[92:93], v[92:93], s[66:67]
    v_pk_add_f32 v[94:95], v[94:95], s[66:67]
    v_pk_fma_f32 v[88:89], v[88:89], v[88:89], s[66:67]
    v_pk_fma_f32 v[90:91], v[90:91], v[90:91], s[66:67]
    v_pk_fma_f32 v[92:93], v[92:93], v[92:93], s[66:67]
    v_pk_fma_f32 v[94:95], v[94:95], v[94:95], s[66:67]
    v_rcp_f32 v88, v88
    v_rcp_f32 v89, v89
    v_rcp_f32 v90, v90
    v_rcp_f32 v91, v91
    v_rcp_f32 v92, v92
    v_rcp_f32 v93, v93
    v_rcp_f32 v94, v94
    v_rcp_f32 v95, v95
    v_pk_fma_f32 v[88:89], v[88:89], v[164:165], s[66:67]
    v_pk_fma_f32 v[90:91], v[90:91], v[164:165], s[66:67]
    v_pk_fma_f32 v[92:93], v[92:93], v[164:165], s[66:67]
    v_pk_fma_f32 v[94:95], v[94:95], v[164:165], s[66:67]
    v_pk_mul_f32 v[88:89], v[88:89], v[104:105]
    v_pk_mul_f32 v[90:91], v[90:91], v[106:107]
    v_pk_mul_f32 v[92:93], v[92:93], v[108:109]
    v_pk_mul_f32 v[94:95], v[94:95], v[110:111]
    v_cvt_pk_bf16_f32 v120, v88, v89
    v_cvt_pk_bf16_f32 v121, v90, v91
    v_cvt_pk_bf16_f32 v122, v92, v93
    v_cvt_pk_bf16_f32 v123, v94, v95
    buffer_store_dwordx4 v[120:123], v152, s[28:31], s61 offen sc1
    s_add_u32 s61, s61, 1024
    s_add_u32 s62, s62, 1024
    s_add_u32 s63, s63, 16
    s_cmp_lt_u32 s63, 64
    s_cbranch_scc1 gated_mix__sliding_local_dilated__dense_activation_mish__prompt_kernel_ml2
    s_branch gated_mix__sliding_local_dilated__dense_activation_mish__prompt_kernel_done
gated_mix__sliding_local_dilated__dense_activation_mish__prompt_kernel_done:
    s_waitcnt vmcnt(0) lgkmcnt(0)
    s_setprio 0
    s_barrier
    s_lshl_b32 s62, s48, 12
    s_mul_i32 s63, s48, 5120
    s_lshr_b32 s25, s20, 1
    s_lshl_b32 s25, s25, 8
    s_add_u32 s25, s25, 15204352
    s_cmp_lt_u32 s50, 2
    s_cselect_b32 s61, 0, 8
    v_and_b32 v0, 15, v153
    v_or_b32 v0, s61, v0
    v_lshlrev_b32 v0, 2, v0
    s_add_u32 m0, s24, 0
    s_nop 0
    buffer_load_dwordx4 v152, s[28:31], s23 offen offset:0 lds
    buffer_load_dwordx4 v152, s[28:31], s23 offen offset:1024 lds
    buffer_load_dwordx4 v152, s[28:31], s23 offen offset:2048 lds
    buffer_load_dwordx4 v152, s[28:31], s23 offen offset:3072 lds
    s_add_u32 m0, s24, 4096
    s_add_u32 s60, s23, 4096
    buffer_load_dwordx4 v152, s[28:31], s60 offen lds
    s_add_u32 s23, s23, 5120
    s_add_u32 s27, s27, 1
    s_cmp_eq_u32 s27, s48
    s_cselect_b32 s60, s63, 0
    s_cselect_b32 s27, 0, s27
    s_sub_u32 s23, s23, s60
    buffer_load_dword v1, v0, s[28:31], s25 offen sc1
    s_add_u32 m0, s24, 40960
    s_nop 0
    buffer_load_dwordx4 v152, s[28:31], s23 offen offset:0 lds
    buffer_load_dwordx4 v152, s[28:31], s23 offen offset:1024 lds
    buffer_load_dwordx4 v152, s[28:31], s23 offen offset:2048 lds
    buffer_load_dwordx4 v152, s[28:31], s23 offen offset:3072 lds
    s_add_u32 m0, s24, 45056
    s_add_u32 s60, s23, 4096
    buffer_load_dwordx4 v152, s[28:31], s60 offen lds
    s_add_u32 s23, s23, 5120
    s_add_u32 s27, s27, 1
    s_cmp_eq_u32 s27, s48
    s_cselect_b32 s60, s63, 0
    s_cselect_b32 s27, 0, s27
    s_sub_u32 s23, s23, s60
    s_waitcnt vmcnt(5)
    s_mov_b32 s61, 0
gated_mix__sliding_local_dilated__dense_activation_mish__prompt_kernel_poll:
    v_cmp_ne_u32 vcc, 1, v1
    s_cbranch_vccz gated_mix__sliding_local_dilated__dense_activation_mish__prompt_kernel_go
    s_add_u32 s61, s61, 1
    s_cmp_gt_u32 s61, 0x8000
    s_cbranch_scc1 gated_mix__sliding_local_dilated__dense_activation_mish__prompt_kernel_go
    s_sleep 5
    buffer_load_dword v1, v0, s[28:31], s25 offen sc1
    s_waitcnt vmcnt(0)
    s_branch gated_mix__sliding_local_dilated__dense_activation_mish__prompt_kernel_poll
gated_mix__sliding_local_dilated__dense_activation_mish__prompt_kernel_go:
    s_lshl_b32 s60, s20, 6
    s_lshr_b32 s61, s50, 1
    s_lshl_b32 s61, s61, 4
    s_add_u32 s60, s60, s61
    v_and_b32 v80, 15, v153
    v_add_u32 v80, s60, v80
    v_lshlrev_b32 v148, 2, v80
    s_mov_b32 s61, 14680064
    buffer_load_dword v148, v148, s[28:31], s61 offen
    v_add_u32 v150, s24, v152
    v_mov_b32 v149, v152
    v_add_u32 v151, 0x14000, v150
    s_lshl_b32 s62, s48, 12
    s_mul_i32 s63, s48, 5120
    s_cmp_lt_u32 s50, 2
    s_cbranch_scc0 gated_mix__sliding_local_dilated__dense_activation_mish__prompt_kernel_b9
    buffer_load_dwordx4 v[80:83], v149, s[28:31], s22 offen offset:0
    buffer_load_dwordx4 v[84:87], v149, s[28:31], s22 offen offset:1024
    buffer_load_dwordx4 v[88:91], v149, s[28:31], s22 offen offset:2048
    buffer_load_dwordx4 v[92:95], v149, s[28:31], s22 offen offset:3072
    s_add_u32 s22, s22, 4096
    s_add_u32 s26, s26, 1
    s_cmp_eq_u32 s26, s48
    s_cselect_b32 s60, s62, 0
    s_cselect_b32 s26, 0, s26
    s_sub_u32 s22, s22, s60
    buffer_load_dwordx4 v[96:99], v149, s[28:31], s22 offen offset:0
    buffer_load_dwordx4 v[100:103], v149, s[28:31], s22 offen offset:1024
    buffer_load_dwordx4 v[104:107], v149, s[28:31], s22 offen offset:2048
    buffer_load_dwordx4 v[108:111], v149, s[28:31], s22 offen offset:3072
    s_add_u32 s22, s22, 4096
    s_add_u32 s26, s26, 1
    s_cmp_eq_u32 s26, s48
    s_cselect_b32 s60, s62, 0
    s_cselect_b32 s26, 0, s26
    s_sub_u32 s22, s22, s60
    v_lshrrev_b32 v112, 1, v149
    buffer_load_dwordx2 v[114:115], v112, s[28:31], s22 offen offset:512
    buffer_load_dwordx2 v[112:113], v112, s[28:31], s22 offen offset:0
    v_lshrrev_b32 v116, 1, v149
    buffer_load_dwordx2 v[118:119], v116, s[28:31], s22 offen offset:1536
    buffer_load_dwordx2 v[116:117], v116, s[28:31], s22 offen offset:1024
    v_lshrrev_b32 v120, 1, v149
    buffer_load_dwordx2 v[122:123], v120, s[28:31], s22 offen offset:2560
    buffer_load_dwordx2 v[120:121], v120, s[28:31], s22 offen offset:2048
    v_lshrrev_b32 v124, 1, v149
    buffer_load_dwordx2 v[126:127], v124, s[28:31], s22 offen offset:3584
    buffer_load_dwordx2 v[124:125], v124, s[28:31], s22 offen offset:3072
    s_add_u32 s22, s22, 4096
    s_add_u32 s26, s26, 1
    s_cmp_eq_u32 s26, s48
    s_cselect_b32 s60, s62, 0
    s_cselect_b32 s26, 0, s26
    s_sub_u32 s22, s22, s60
    ds_read_b128 v[128:131], v151 offset:0
    ds_read_b128 v[132:135], v151 offset:1024
    ds_read_b128 v[136:139], v151 offset:2048
    ds_read_b128 v[140:143], v151 offset:3072
    ds_read_b128 v[144:147], v151 offset:4096
    s_waitcnt vmcnt(12) lgkmcnt(1)
    v_mfma_f32_16x16x32_bf16 v[0:3], v[128:131], v[80:83], 0
    v_mfma_f32_16x16x32_bf16 v[20:23], v[128:131], v[84:87], 0
    buffer_load_dwordx4 v[152:155], v149, s[28:31], s22 offen offset:0
    v_mfma_f32_16x16x32_bf16 v[40:43], v[128:131], v[88:91], 0
    v_mfma_f32_16x16x32_bf16 v[60:63], v[128:131], v[92:95], 0
    ds_read_b128 v[128:131], v151 offset:40960
    v_mfma_f32_16x16x32_bf16 v[4:7], v[132:135], v[80:83], 0
    v_mfma_f32_16x16x32_bf16 v[24:27], v[132:135], v[84:87], 0
    buffer_load_dwordx4 v[156:159], v149, s[28:31], s22 offen offset:1024
    v_mfma_f32_16x16x32_bf16 v[44:47], v[132:135], v[88:91], 0
    v_mfma_f32_16x16x32_bf16 v[64:67], v[132:135], v[92:95], 0
    ds_read_b128 v[132:135], v151 offset:41984
    v_mfma_f32_16x16x32_bf16 v[8:11], v[136:139], v[80:83], 0
    v_mfma_f32_16x16x32_bf16 v[28:31], v[136:139], v[84:87], 0
    buffer_load_dwordx4 v[160:163], v149, s[28:31], s22 offen offset:2048
    v_mfma_f32_16x16x32_bf16 v[48:51], v[136:139], v[88:91], 0
    v_mfma_f32_16x16x32_bf16 v[68:71], v[136:139], v[92:95], 0
    ds_read_b128 v[136:139], v151 offset:43008
    v_mfma_f32_16x16x32_bf16 v[12:15], v[140:143], v[80:83], 0
    v_mfma_f32_16x16x32_bf16 v[32:35], v[140:143], v[84:87], 0
    buffer_load_dwordx4 v[164:167], v149, s[28:31], s22 offen offset:3072
    s_add_u32 s22, s22, 4096
    s_add_u32 s26, s26, 1
    s_cmp_eq_u32 s26, s48
    s_cselect_b32 s60, s62, 0
    s_cselect_b32 s26, 0, s26
    s_sub_u32 s22, s22, s60
    v_mfma_f32_16x16x32_bf16 v[52:55], v[140:143], v[88:91], 0
    v_mfma_f32_16x16x32_bf16 v[72:75], v[140:143], v[92:95], 0
    ds_read_b128 v[140:143], v151 offset:44032
    s_waitcnt lgkmcnt(4)
    v_mfma_f32_16x16x32_bf16 v[16:19], v[144:147], v[80:83], 0
    s_add_u32 m0, s24, 81920
    s_nop 0
    buffer_load_dwordx4 v149, s[28:31], s23 offen offset:0 lds
    v_mfma_f32_16x16x32_bf16 v[36:39], v[144:147], v[84:87], 0
    buffer_load_dwordx4 v149, s[28:31], s23 offen offset:1024 lds
    v_mfma_f32_16x16x32_bf16 v[56:59], v[144:147], v[88:91], 0
    buffer_load_dwordx4 v149, s[28:31], s23 offen offset:2048 lds
    v_mfma_f32_16x16x32_bf16 v[76:79], v[144:147], v[92:95], 0
    buffer_load_dwordx4 v149, s[28:31], s23 offen offset:3072 lds
    ds_read_b128 v[144:147], v151 offset:45056
    s_add_u32 m0, s24, 86016
    s_add_u32 s60, s23, 4096
    buffer_load_dwordx4 v149, s[28:31], s60 offen lds
    s_add_u32 s23, s23, 5120
    s_add_u32 s27, s27, 1
    s_cmp_eq_u32 s27, s48
    s_cselect_b32 s60, s63, 0
    s_cselect_b32 s27, 0, s27
    s_sub_u32 s23, s23, s60
    s_waitcnt vmcnt(17) lgkmcnt(1)
    v_mfma_f32_16x16x32_bf16 v[0:3], v[128:131], v[96:99], v[0:3]
    v_mfma_f32_16x16x32_bf16 v[20:23], v[128:131], v[100:103], v[20:23]
    buffer_load_dwordx4 v[80:83], v149, s[28:31], s22 offen offset:0
    v_mfma_f32_16x16x32_bf16 v[40:43], v[128:131], v[104:107], v[40:43]
    v_mfma_f32_16x16x32_bf16 v[60:63], v[128:131], v[108:111], v[60:63]
    ds_read_b128 v[128:131], v150 offset:0
    v_mfma_f32_16x16x32_bf16 v[4:7], v[132:135], v[96:99], v[4:7]
    v_mfma_f32_16x16x32_bf16 v[24:27], v[132:135], v[100:103], v[24:27]
    buffer_load_dwordx4 v[84:87], v149, s[28:31], s22 offen offset:1024
    v_mfma_f32_16x16x32_bf16 v[44:47], v[132:135], v[104:107], v[44:47]
    v_mfma_f32_16x16x32_bf16 v[64:67], v[132:135], v[108:111], v[64:67]
    ds_read_b128 v[132:135], v150 offset:1024
    v_mfma_f32_16x16x32_bf16 v[8:11], v[136:139], v[96:99], v[8:11]
    v_mfma_f32_16x16x32_bf16 v[28:31], v[136:139], v[100:103], v[28:31]
    buffer_load_dwordx4 v[88:91], v149, s[28:31], s22 offen offset:2048
    v_mfma_f32_16x16x32_bf16 v[48:51], v[136:139], v[104:107], v[48:51]
    v_mfma_f32_16x16x32_bf16 v[68:71], v[136:139], v[108:111], v[68:71]
    ds_read_b128 v[136:139], v150 offset:2048
    v_mfma_f32_16x16x32_bf16 v[12:15], v[140:143], v[96:99], v[12:15]
    v_mfma_f32_16x16x32_bf16 v[32:35], v[140:143], v[100:103], v[32:35]
    buffer_load_dwordx4 v[92:95], v149, s[28:31], s22 offen offset:3072
    s_add_u32 s22, s22, 4096
    s_add_u32 s26, s26, 1
    s_cmp_eq_u32 s26, s48
    s_cselect_b32 s60, s62, 0
    s_cselect_b32 s26, 0, s26
    s_sub_u32 s22, s22, s60
    v_mfma_f32_16x16x32_bf16 v[52:55], v[140:143], v[104:107], v[52:55]
    v_mfma_f32_16x16x32_bf16 v[72:75], v[140:143], v[108:111], v[72:75]
    ds_read_b128 v[140:143], v150 offset:3072
    s_waitcnt lgkmcnt(4)
    v_mfma_f32_16x16x32_bf16 v[16:19], v[144:147], v[96:99], v[16:19]
    s_add_u32 m0, s24, 122880
    s_nop 0
    buffer_load_dwordx4 v149, s[28:31], s23 offen offset:0 lds
    v_mfma_f32_16x16x32_bf16 v[36:39], v[144:147], v[100:103], v[36:39]
    buffer_load_dwordx4 v149, s[28:31], s23 offen offset:1024 lds
    v_mfma_f32_16x16x32_bf16 v[56:59], v[144:147], v[104:107], v[56:59]
    buffer_load_dwordx4 v149, s[28:31], s23 offen offset:2048 lds
    v_mfma_f32_16x16x32_bf16 v[76:79], v[144:147], v[108:111], v[76:79]
    buffer_load_dwordx4 v149, s[28:31], s23 offen offset:3072 lds
    ds_read_b128 v[144:147], v150 offset:4096
    s_add_u32 m0, s24, 126976
    s_add_u32 s60, s23, 4096
    buffer_load_dwordx4 v149, s[28:31], s60 offen lds
    s_add_u32 s23, s23, 5120
    s_add_u32 s27, s27, 1
    s_cmp_eq_u32 s27, s48
    s_cselect_b32 s60, s63, 0
    s_cselect_b32 s27, 0, s27
    s_sub_u32 s23, s23, s60
    s_waitcnt vmcnt(18) lgkmcnt(1)
    v_mfma_f32_16x16x32_bf16 v[0:3], v[128:131], v[112:115], v[0:3]
    v_mfma_f32_16x16x32_bf16 v[20:23], v[128:131], v[116:119], v[20:23]
    buffer_load_dwordx4 v[96:99], v149, s[28:31], s22 offen offset:0
    v_mfma_f32_16x16x32_bf16 v[40:43], v[128:131], v[120:123], v[40:43]
    v_mfma_f32_16x16x32_bf16 v[60:63], v[128:131], v[124:127], v[60:63]
    ds_read_b128 v[128:131], v150 offset:40960
    v_mfma_f32_16x16x32_bf16 v[4:7], v[132:135], v[112:115], v[4:7]
    v_mfma_f32_16x16x32_bf16 v[24:27], v[132:135], v[116:119], v[24:27]
    buffer_load_dwordx4 v[100:103], v149, s[28:31], s22 offen offset:1024
    v_mfma_f32_16x16x32_bf16 v[44:47], v[132:135], v[120:123], v[44:47]
    v_mfma_f32_16x16x32_bf16 v[64:67], v[132:135], v[124:127], v[64:67]
    ds_read_b128 v[132:135], v150 offset:41984
    v_mfma_f32_16x16x32_bf16 v[8:11], v[136:139], v[112:115], v[8:11]
    v_mfma_f32_16x16x32_bf16 v[28:31], v[136:139], v[116:119], v[28:31]
    buffer_load_dwordx4 v[104:107], v149, s[28:31], s22 offen offset:2048
    v_mfma_f32_16x16x32_bf16 v[48:51], v[136:139], v[120:123], v[48:51]
    v_mfma_f32_16x16x32_bf16 v[68:71], v[136:139], v[124:127], v[68:71]
    ds_read_b128 v[136:139], v150 offset:43008
    v_mfma_f32_16x16x32_bf16 v[12:15], v[140:143], v[112:115], v[12:15]
    v_mfma_f32_16x16x32_bf16 v[32:35], v[140:143], v[116:119], v[32:35]
    buffer_load_dwordx4 v[108:111], v149, s[28:31], s22 offen offset:3072
    s_add_u32 s22, s22, 4096
    s_add_u32 s26, s26, 1
    s_cmp_eq_u32 s26, s48
    s_cselect_b32 s60, s62, 0
    s_cselect_b32 s26, 0, s26
    s_sub_u32 s22, s22, s60
    v_mfma_f32_16x16x32_bf16 v[52:55], v[140:143], v[120:123], v[52:55]
    v_mfma_f32_16x16x32_bf16 v[72:75], v[140:143], v[124:127], v[72:75]
    ds_read_b128 v[140:143], v150 offset:44032
    s_waitcnt lgkmcnt(4)
    v_mfma_f32_16x16x32_bf16 v[16:19], v[144:147], v[112:115], v[16:19]
    s_add_u32 m0, s24, 0
    s_nop 0
    buffer_load_dwordx4 v149, s[28:31], s23 offen offset:0 lds
    v_mfma_f32_16x16x32_bf16 v[36:39], v[144:147], v[116:119], v[36:39]
    buffer_load_dwordx4 v149, s[28:31], s23 offen offset:1024 lds
    v_mfma_f32_16x16x32_bf16 v[56:59], v[144:147], v[120:123], v[56:59]
    buffer_load_dwordx4 v149, s[28:31], s23 offen offset:2048 lds
    v_mfma_f32_16x16x32_bf16 v[76:79], v[144:147], v[124:127], v[76:79]
    buffer_load_dwordx4 v149, s[28:31], s23 offen offset:3072 lds
    ds_read_b128 v[144:147], v150 offset:45056
    s_add_u32 m0, s24, 4096
    s_add_u32 s60, s23, 4096
    buffer_load_dwordx4 v149, s[28:31], s60 offen lds
    s_add_u32 s23, s23, 5120
    s_add_u32 s27, s27, 1
    s_cmp_eq_u32 s27, s48
    s_cselect_b32 s60, s63, 0
    s_cselect_b32 s27, 0, s27
    s_sub_u32 s23, s23, s60
    s_waitcnt vmcnt(18) lgkmcnt(1)
    v_mfma_f32_16x16x32_bf16 v[0:3], v[128:131], v[152:155], v[0:3]
    v_mfma_f32_16x16x32_bf16 v[20:23], v[128:131], v[156:159], v[20:23]
    buffer_load_dwordx4 v[112:115], v149, s[28:31], s22 offen offset:0
    v_mfma_f32_16x16x32_bf16 v[40:43], v[128:131], v[160:163], v[40:43]
    v_mfma_f32_16x16x32_bf16 v[60:63], v[128:131], v[164:167], v[60:63]
    ds_read_b128 v[128:131], v151 offset:0
    v_mfma_f32_16x16x32_bf16 v[4:7], v[132:135], v[152:155], v[4:7]
    v_mfma_f32_16x16x32_bf16 v[24:27], v[132:135], v[156:159], v[24:27]
    buffer_load_dwordx4 v[116:119], v149, s[28:31], s22 offen offset:1024
    v_mfma_f32_16x16x32_bf16 v[44:47], v[132:135], v[160:163], v[44:47]
    v_mfma_f32_16x16x32_bf16 v[64:67], v[132:135], v[164:167], v[64:67]
    ds_read_b128 v[132:135], v151 offset:1024
    v_mfma_f32_16x16x32_bf16 v[8:11], v[136:139], v[152:155], v[8:11]
    v_mfma_f32_16x16x32_bf16 v[28:31], v[136:139], v[156:159], v[28:31]
    buffer_load_dwordx4 v[120:123], v149, s[28:31], s22 offen offset:2048
    v_mfma_f32_16x16x32_bf16 v[48:51], v[136:139], v[160:163], v[48:51]
    v_mfma_f32_16x16x32_bf16 v[68:71], v[136:139], v[164:167], v[68:71]
    ds_read_b128 v[136:139], v151 offset:2048
    v_mfma_f32_16x16x32_bf16 v[12:15], v[140:143], v[152:155], v[12:15]
    v_mfma_f32_16x16x32_bf16 v[32:35], v[140:143], v[156:159], v[32:35]
    buffer_load_dwordx4 v[124:127], v149, s[28:31], s22 offen offset:3072
    s_add_u32 s22, s22, 4096
    s_add_u32 s26, s26, 1
    s_cmp_eq_u32 s26, s48
    s_cselect_b32 s60, s62, 0
    s_cselect_b32 s26, 0, s26
    s_sub_u32 s22, s22, s60
    v_mfma_f32_16x16x32_bf16 v[52:55], v[140:143], v[160:163], v[52:55]
    v_mfma_f32_16x16x32_bf16 v[72:75], v[140:143], v[164:167], v[72:75]
    ds_read_b128 v[140:143], v151 offset:3072
    s_waitcnt lgkmcnt(4)
    v_mfma_f32_16x16x32_bf16 v[16:19], v[144:147], v[152:155], v[16:19]
    s_add_u32 m0, s24, 40960
    s_nop 0
    buffer_load_dwordx4 v149, s[28:31], s23 offen offset:0 lds
    v_mfma_f32_16x16x32_bf16 v[36:39], v[144:147], v[156:159], v[36:39]
    buffer_load_dwordx4 v149, s[28:31], s23 offen offset:1024 lds
    v_mfma_f32_16x16x32_bf16 v[56:59], v[144:147], v[160:163], v[56:59]
    buffer_load_dwordx4 v149, s[28:31], s23 offen offset:2048 lds
    v_mfma_f32_16x16x32_bf16 v[76:79], v[144:147], v[164:167], v[76:79]
    buffer_load_dwordx4 v149, s[28:31], s23 offen offset:3072 lds
    ds_read_b128 v[144:147], v151 offset:4096
    s_add_u32 m0, s24, 45056
    s_add_u32 s60, s23, 4096
    buffer_load_dwordx4 v149, s[28:31], s60 offen lds
    s_add_u32 s23, s23, 5120
    s_add_u32 s27, s27, 1
    s_cmp_eq_u32 s27, s48
    s_cselect_b32 s60, s63, 0
    s_cselect_b32 s27, 0, s27
    s_sub_u32 s23, s23, s60
    s_waitcnt vmcnt(18) lgkmcnt(1)
    v_mfma_f32_16x16x32_bf16 v[0:3], v[128:131], v[80:83], v[0:3]
    v_mfma_f32_16x16x32_bf16 v[20:23], v[128:131], v[84:87], v[20:23]
    v_lshrrev_b32 v152, 1, v149
    buffer_load_dwordx2 v[154:155], v152, s[28:31], s22 offen offset:512
    buffer_load_dwordx2 v[152:153], v152, s[28:31], s22 offen offset:0
    v_mfma_f32_16x16x32_bf16 v[40:43], v[128:131], v[88:91], v[40:43]
    v_mfma_f32_16x16x32_bf16 v[60:63], v[128:131], v[92:95], v[60:63]
    ds_read_b128 v[128:131], v151 offset:40960
    v_mfma_f32_16x16x32_bf16 v[4:7], v[132:135], v[80:83], v[4:7]
    v_mfma_f32_16x16x32_bf16 v[24:27], v[132:135], v[84:87], v[24:27]
    v_lshrrev_b32 v156, 1, v149
    buffer_load_dwordx2 v[158:159], v156, s[28:31], s22 offen offset:1536
    buffer_load_dwordx2 v[156:157], v156, s[28:31], s22 offen offset:1024
    v_mfma_f32_16x16x32_bf16 v[44:47], v[132:135], v[88:91], v[44:47]
    v_mfma_f32_16x16x32_bf16 v[64:67], v[132:135], v[92:95], v[64:67]
    ds_read_b128 v[132:135], v151 offset:41984
    v_mfma_f32_16x16x32_bf16 v[8:11], v[136:139], v[80:83], v[8:11]
    v_mfma_f32_16x16x32_bf16 v[28:31], v[136:139], v[84:87], v[28:31]
    v_lshrrev_b32 v160, 1, v149
    buffer_load_dwordx2 v[162:163], v160, s[28:31], s22 offen offset:2560
    buffer_load_dwordx2 v[160:161], v160, s[28:31], s22 offen offset:2048
    v_mfma_f32_16x16x32_bf16 v[48:51], v[136:139], v[88:91], v[48:51]
    v_mfma_f32_16x16x32_bf16 v[68:71], v[136:139], v[92:95], v[68:71]
    ds_read_b128 v[136:139], v151 offset:43008
    v_mfma_f32_16x16x32_bf16 v[12:15], v[140:143], v[80:83], v[12:15]
    v_mfma_f32_16x16x32_bf16 v[32:35], v[140:143], v[84:87], v[32:35]
    v_lshrrev_b32 v164, 1, v149
    buffer_load_dwordx2 v[166:167], v164, s[28:31], s22 offen offset:3584
    buffer_load_dwordx2 v[164:165], v164, s[28:31], s22 offen offset:3072
    s_add_u32 s22, s22, 4096
    s_add_u32 s26, s26, 1
    s_cmp_eq_u32 s26, s48
    s_cselect_b32 s60, s62, 0
    s_cselect_b32 s26, 0, s26
    s_sub_u32 s22, s22, s60
    v_mfma_f32_16x16x32_bf16 v[52:55], v[140:143], v[88:91], v[52:55]
    v_mfma_f32_16x16x32_bf16 v[72:75], v[140:143], v[92:95], v[72:75]
    ds_read_b128 v[140:143], v151 offset:44032
    s_waitcnt lgkmcnt(4)
    v_mfma_f32_16x16x32_bf16 v[16:19], v[144:147], v[80:83], v[16:19]
    s_add_u32 m0, s24, 81920
    s_nop 0
    buffer_load_dwordx4 v149, s[28:31], s23 offen offset:0 lds
    v_mfma_f32_16x16x32_bf16 v[36:39], v[144:147], v[84:87], v[36:39]
    buffer_load_dwordx4 v149, s[28:31], s23 offen offset:1024 lds
    v_mfma_f32_16x16x32_bf16 v[56:59], v[144:147], v[88:91], v[56:59]
    buffer_load_dwordx4 v149, s[28:31], s23 offen offset:2048 lds
    v_mfma_f32_16x16x32_bf16 v[76:79], v[144:147], v[92:95], v[76:79]
    buffer_load_dwordx4 v149, s[28:31], s23 offen offset:3072 lds
    ds_read_b128 v[144:147], v151 offset:45056
    s_add_u32 m0, s24, 86016
    s_add_u32 s60, s23, 4096
    buffer_load_dwordx4 v149, s[28:31], s60 offen lds
    s_add_u32 s23, s23, 5120
    s_add_u32 s27, s27, 1
    s_cmp_eq_u32 s27, s48
    s_cselect_b32 s60, s63, 0
    s_cselect_b32 s27, 0, s27
    s_sub_u32 s23, s23, s60
    s_waitcnt vmcnt(22) lgkmcnt(1)
    v_mfma_f32_16x16x32_bf16 v[0:3], v[128:131], v[96:99], v[0:3]
    v_mfma_f32_16x16x32_bf16 v[20:23], v[128:131], v[100:103], v[20:23]
    buffer_load_dwordx4 v[80:83], v149, s[28:31], s22 offen offset:0
    v_mfma_f32_16x16x32_bf16 v[40:43], v[128:131], v[104:107], v[40:43]
    v_mfma_f32_16x16x32_bf16 v[60:63], v[128:131], v[108:111], v[60:63]
    ds_read_b128 v[128:131], v150 offset:0
    v_mfma_f32_16x16x32_bf16 v[4:7], v[132:135], v[96:99], v[4:7]
    v_mfma_f32_16x16x32_bf16 v[24:27], v[132:135], v[100:103], v[24:27]
    buffer_load_dwordx4 v[84:87], v149, s[28:31], s22 offen offset:1024
    v_mfma_f32_16x16x32_bf16 v[44:47], v[132:135], v[104:107], v[44:47]
    v_mfma_f32_16x16x32_bf16 v[64:67], v[132:135], v[108:111], v[64:67]
    ds_read_b128 v[132:135], v150 offset:1024
    v_mfma_f32_16x16x32_bf16 v[8:11], v[136:139], v[96:99], v[8:11]
    v_mfma_f32_16x16x32_bf16 v[28:31], v[136:139], v[100:103], v[28:31]
    buffer_load_dwordx4 v[88:91], v149, s[28:31], s22 offen offset:2048
    v_mfma_f32_16x16x32_bf16 v[48:51], v[136:139], v[104:107], v[48:51]
    v_mfma_f32_16x16x32_bf16 v[68:71], v[136:139], v[108:111], v[68:71]
    ds_read_b128 v[136:139], v150 offset:2048
    v_mfma_f32_16x16x32_bf16 v[12:15], v[140:143], v[96:99], v[12:15]
    v_mfma_f32_16x16x32_bf16 v[32:35], v[140:143], v[100:103], v[32:35]
    buffer_load_dwordx4 v[92:95], v149, s[28:31], s22 offen offset:3072
    s_add_u32 s22, s22, 4096
    s_add_u32 s26, s26, 1
    s_cmp_eq_u32 s26, s48
    s_cselect_b32 s60, s62, 0
    s_cselect_b32 s26, 0, s26
    s_sub_u32 s22, s22, s60
    v_mfma_f32_16x16x32_bf16 v[52:55], v[140:143], v[104:107], v[52:55]
    v_mfma_f32_16x16x32_bf16 v[72:75], v[140:143], v[108:111], v[72:75]
    ds_read_b128 v[140:143], v150 offset:3072
    s_waitcnt lgkmcnt(4)
    v_mfma_f32_16x16x32_bf16 v[16:19], v[144:147], v[96:99], v[16:19]
    s_add_u32 m0, s24, 122880
    s_nop 0
    buffer_load_dwordx4 v149, s[28:31], s23 offen offset:0 lds
    v_mfma_f32_16x16x32_bf16 v[36:39], v[144:147], v[100:103], v[36:39]
    buffer_load_dwordx4 v149, s[28:31], s23 offen offset:1024 lds
    v_mfma_f32_16x16x32_bf16 v[56:59], v[144:147], v[104:107], v[56:59]
    buffer_load_dwordx4 v149, s[28:31], s23 offen offset:2048 lds
    v_mfma_f32_16x16x32_bf16 v[76:79], v[144:147], v[108:111], v[76:79]
    buffer_load_dwordx4 v149, s[28:31], s23 offen offset:3072 lds
    ds_read_b128 v[144:147], v150 offset:4096
    s_add_u32 m0, s24, 126976
    s_add_u32 s60, s23, 4096
    buffer_load_dwordx4 v149, s[28:31], s60 offen lds
    s_add_u32 s23, s23, 5120
    s_add_u32 s27, s27, 1
    s_cmp_eq_u32 s27, s48
    s_cselect_b32 s60, s63, 0
    s_cselect_b32 s27, 0, s27
    s_sub_u32 s23, s23, s60
    s_waitcnt vmcnt(22) lgkmcnt(1)
    v_mfma_f32_16x16x32_bf16 v[0:3], v[128:131], v[112:115], v[0:3]
    v_mfma_f32_16x16x32_bf16 v[20:23], v[128:131], v[116:119], v[20:23]
    buffer_load_dwordx4 v[96:99], v149, s[28:31], s22 offen offset:0
    v_mfma_f32_16x16x32_bf16 v[40:43], v[128:131], v[120:123], v[40:43]
    v_mfma_f32_16x16x32_bf16 v[60:63], v[128:131], v[124:127], v[60:63]
    ds_read_b128 v[128:131], v150 offset:40960
    v_mfma_f32_16x16x32_bf16 v[4:7], v[132:135], v[112:115], v[4:7]
    v_mfma_f32_16x16x32_bf16 v[24:27], v[132:135], v[116:119], v[24:27]
    buffer_load_dwordx4 v[100:103], v149, s[28:31], s22 offen offset:1024
    v_mfma_f32_16x16x32_bf16 v[44:47], v[132:135], v[120:123], v[44:47]
    v_mfma_f32_16x16x32_bf16 v[64:67], v[132:135], v[124:127], v[64:67]
    ds_read_b128 v[132:135], v150 offset:41984
    v_mfma_f32_16x16x32_bf16 v[8:11], v[136:139], v[112:115], v[8:11]
    v_mfma_f32_16x16x32_bf16 v[28:31], v[136:139], v[116:119], v[28:31]
    buffer_load_dwordx4 v[104:107], v149, s[28:31], s22 offen offset:2048
    v_mfma_f32_16x16x32_bf16 v[48:51], v[136:139], v[120:123], v[48:51]
    v_mfma_f32_16x16x32_bf16 v[68:71], v[136:139], v[124:127], v[68:71]
    ds_read_b128 v[136:139], v150 offset:43008
    v_mfma_f32_16x16x32_bf16 v[12:15], v[140:143], v[112:115], v[12:15]
    v_mfma_f32_16x16x32_bf16 v[32:35], v[140:143], v[116:119], v[32:35]
    buffer_load_dwordx4 v[108:111], v149, s[28:31], s22 offen offset:3072
    s_add_u32 s22, s22, 4096
    s_add_u32 s26, s26, 1
    s_cmp_eq_u32 s26, s48
    s_cselect_b32 s60, s62, 0
    s_cselect_b32 s26, 0, s26
    s_sub_u32 s22, s22, s60
    v_mfma_f32_16x16x32_bf16 v[52:55], v[140:143], v[120:123], v[52:55]
    v_mfma_f32_16x16x32_bf16 v[72:75], v[140:143], v[124:127], v[72:75]
    ds_read_b128 v[140:143], v150 offset:44032
    s_waitcnt lgkmcnt(4)
    v_mfma_f32_16x16x32_bf16 v[16:19], v[144:147], v[112:115], v[16:19]
    v_mfma_f32_16x16x32_bf16 v[36:39], v[144:147], v[116:119], v[36:39]
    v_mfma_f32_16x16x32_bf16 v[56:59], v[144:147], v[120:123], v[56:59]
    v_mfma_f32_16x16x32_bf16 v[76:79], v[144:147], v[124:127], v[76:79]
    ds_read_b128 v[144:147], v150 offset:45056
    s_waitcnt vmcnt(13) lgkmcnt(1)
    v_mfma_f32_16x16x32_bf16 v[0:3], v[128:131], v[152:155], v[0:3]
    v_mfma_f32_16x16x32_bf16 v[20:23], v[128:131], v[156:159], v[20:23]
    v_mfma_f32_16x16x32_bf16 v[40:43], v[128:131], v[160:163], v[40:43]
    v_mfma_f32_16x16x32_bf16 v[60:63], v[128:131], v[164:167], v[60:63]
    ds_read_b128 v[128:131], v151 offset:0
    v_mfma_f32_16x16x32_bf16 v[4:7], v[132:135], v[152:155], v[4:7]
    v_mfma_f32_16x16x32_bf16 v[24:27], v[132:135], v[156:159], v[24:27]
    v_mfma_f32_16x16x32_bf16 v[44:47], v[132:135], v[160:163], v[44:47]
    v_mfma_f32_16x16x32_bf16 v[64:67], v[132:135], v[164:167], v[64:67]
    ds_read_b128 v[132:135], v151 offset:1024
    v_mfma_f32_16x16x32_bf16 v[8:11], v[136:139], v[152:155], v[8:11]
    v_mfma_f32_16x16x32_bf16 v[28:31], v[136:139], v[156:159], v[28:31]
    v_mfma_f32_16x16x32_bf16 v[48:51], v[136:139], v[160:163], v[48:51]
    v_mfma_f32_16x16x32_bf16 v[68:71], v[136:139], v[164:167], v[68:71]
    ds_read_b128 v[136:139], v151 offset:2048
    v_mfma_f32_16x16x32_bf16 v[12:15], v[140:143], v[152:155], v[12:15]
    v_mfma_f32_16x16x32_bf16 v[32:35], v[140:143], v[156:159], v[32:35]
    v_mfma_f32_16x16x32_bf16 v[52:55], v[140:143], v[160:163], v[52:55]
    v_mfma_f32_16x16x32_bf16 v[72:75], v[140:143], v[164:167], v[72:75]
    ds_read_b128 v[140:143], v151 offset:3072
    s_waitcnt lgkmcnt(4)
    v_mfma_f32_16x16x32_bf16 v[16:19], v[144:147], v[152:155], v[16:19]
    v_mfma_f32_16x16x32_bf16 v[36:39], v[144:147], v[156:159], v[36:39]
    v_mfma_f32_16x16x32_bf16 v[56:59], v[144:147], v[160:163], v[56:59]
    v_mfma_f32_16x16x32_bf16 v[76:79], v[144:147], v[164:167], v[76:79]
    ds_read_b128 v[144:147], v151 offset:4096
    s_waitcnt vmcnt(4) lgkmcnt(1)
    v_mfma_f32_16x16x32_bf16 v[0:3], v[128:131], v[80:83], v[0:3]
    v_mfma_f32_16x16x32_bf16 v[20:23], v[128:131], v[84:87], v[20:23]
    v_mfma_f32_16x16x32_bf16 v[40:43], v[128:131], v[88:91], v[40:43]
    v_mfma_f32_16x16x32_bf16 v[60:63], v[128:131], v[92:95], v[60:63]
    ds_read_b128 v[128:131], v151 offset:40960
    v_mfma_f32_16x16x32_bf16 v[4:7], v[132:135], v[80:83], v[4:7]
    v_mfma_f32_16x16x32_bf16 v[24:27], v[132:135], v[84:87], v[24:27]
    v_mfma_f32_16x16x32_bf16 v[44:47], v[132:135], v[88:91], v[44:47]
    v_mfma_f32_16x16x32_bf16 v[64:67], v[132:135], v[92:95], v[64:67]
    ds_read_b128 v[132:135], v151 offset:41984
    v_mfma_f32_16x16x32_bf16 v[8:11], v[136:139], v[80:83], v[8:11]
    v_mfma_f32_16x16x32_bf16 v[28:31], v[136:139], v[84:87], v[28:31]
    v_mfma_f32_16x16x32_bf16 v[48:51], v[136:139], v[88:91], v[48:51]
    v_mfma_f32_16x16x32_bf16 v[68:71], v[136:139], v[92:95], v[68:71]
    ds_read_b128 v[136:139], v151 offset:43008
    v_mfma_f32_16x16x32_bf16 v[12:15], v[140:143], v[80:83], v[12:15]
    v_mfma_f32_16x16x32_bf16 v[32:35], v[140:143], v[84:87], v[32:35]
    v_mfma_f32_16x16x32_bf16 v[52:55], v[140:143], v[88:91], v[52:55]
    v_mfma_f32_16x16x32_bf16 v[72:75], v[140:143], v[92:95], v[72:75]
    ds_read_b128 v[140:143], v151 offset:44032
    s_waitcnt lgkmcnt(4)
    v_mfma_f32_16x16x32_bf16 v[16:19], v[144:147], v[80:83], v[16:19]
    v_mfma_f32_16x16x32_bf16 v[36:39], v[144:147], v[84:87], v[36:39]
    v_mfma_f32_16x16x32_bf16 v[56:59], v[144:147], v[88:91], v[56:59]
    v_mfma_f32_16x16x32_bf16 v[76:79], v[144:147], v[92:95], v[76:79]
    ds_read_b128 v[144:147], v151 offset:45056
    s_waitcnt vmcnt(0) lgkmcnt(1)
    v_mfma_f32_16x16x32_bf16 v[0:3], v[128:131], v[96:99], v[0:3]
    v_mfma_f32_16x16x32_bf16 v[20:23], v[128:131], v[100:103], v[20:23]
    v_mfma_f32_16x16x32_bf16 v[40:43], v[128:131], v[104:107], v[40:43]
    v_mfma_f32_16x16x32_bf16 v[60:63], v[128:131], v[108:111], v[60:63]
    v_mfma_f32_16x16x32_bf16 v[4:7], v[132:135], v[96:99], v[4:7]
    v_mfma_f32_16x16x32_bf16 v[24:27], v[132:135], v[100:103], v[24:27]
    v_mfma_f32_16x16x32_bf16 v[44:47], v[132:135], v[104:107], v[44:47]
    v_mfma_f32_16x16x32_bf16 v[64:67], v[132:135], v[108:111], v[64:67]
    v_mfma_f32_16x16x32_bf16 v[8:11], v[136:139], v[96:99], v[8:11]
    v_mfma_f32_16x16x32_bf16 v[28:31], v[136:139], v[100:103], v[28:31]
    v_mfma_f32_16x16x32_bf16 v[48:51], v[136:139], v[104:107], v[48:51]
    v_mfma_f32_16x16x32_bf16 v[68:71], v[136:139], v[108:111], v[68:71]
    v_mfma_f32_16x16x32_bf16 v[12:15], v[140:143], v[96:99], v[12:15]
    v_mfma_f32_16x16x32_bf16 v[32:35], v[140:143], v[100:103], v[32:35]
    v_mfma_f32_16x16x32_bf16 v[52:55], v[140:143], v[104:107], v[52:55]
    v_mfma_f32_16x16x32_bf16 v[72:75], v[140:143], v[108:111], v[72:75]
    s_waitcnt lgkmcnt(0)
    v_mfma_f32_16x16x32_bf16 v[16:19], v[144:147], v[96:99], v[16:19]
    v_mfma_f32_16x16x32_bf16 v[36:39], v[144:147], v[100:103], v[36:39]
    v_mfma_f32_16x16x32_bf16 v[56:59], v[144:147], v[104:107], v[56:59]
    v_mfma_f32_16x16x32_bf16 v[76:79], v[144:147], v[108:111], v[76:79]
    s_branch gated_mix__sliding_local_dilated__dense_activation_mish__prompt_kernel_epi2
gated_mix__sliding_local_dilated__dense_activation_mish__prompt_kernel_b9:
    buffer_load_dwordx4 v[80:83], v149, s[28:31], s22 offen offset:0
    buffer_load_dwordx4 v[84:87], v149, s[28:31], s22 offen offset:1024
    buffer_load_dwordx4 v[88:91], v149, s[28:31], s22 offen offset:2048
    buffer_load_dwordx4 v[92:95], v149, s[28:31], s22 offen offset:3072
    s_add_u32 s22, s22, 4096
    s_add_u32 s26, s26, 1
    s_cmp_eq_u32 s26, s48
    s_cselect_b32 s60, s62, 0
    s_cselect_b32 s26, 0, s26
    s_sub_u32 s22, s22, s60
    buffer_load_dwordx4 v[96:99], v149, s[28:31], s22 offen offset:0
    buffer_load_dwordx4 v[100:103], v149, s[28:31], s22 offen offset:1024
    buffer_load_dwordx4 v[104:107], v149, s[28:31], s22 offen offset:2048
    buffer_load_dwordx4 v[108:111], v149, s[28:31], s22 offen offset:3072
    s_add_u32 s22, s22, 4096
    s_add_u32 s26, s26, 1
    s_cmp_eq_u32 s26, s48
    s_cselect_b32 s60, s62, 0
    s_cselect_b32 s26, 0, s26
    s_sub_u32 s22, s22, s60
    buffer_load_dwordx4 v[112:115], v149, s[28:31], s22 offen offset:0
    buffer_load_dwordx4 v[116:119], v149, s[28:31], s22 offen offset:1024
    buffer_load_dwordx4 v[120:123], v149, s[28:31], s22 offen offset:2048
    buffer_load_dwordx4 v[124:127], v149, s[28:31], s22 offen offset:3072
    s_add_u32 s22, s22, 4096
    s_add_u32 s26, s26, 1
    s_cmp_eq_u32 s26, s48
    s_cselect_b32 s60, s62, 0
    s_cselect_b32 s26, 0, s26
    s_sub_u32 s22, s22, s60
    ds_read_b128 v[128:131], v151 offset:0
    ds_read_b128 v[132:135], v151 offset:1024
    ds_read_b128 v[136:139], v151 offset:2048
    ds_read_b128 v[140:143], v151 offset:3072
    ds_read_b128 v[144:147], v151 offset:4096
    s_waitcnt vmcnt(8) lgkmcnt(1)
    v_mfma_f32_16x16x32_bf16 v[0:3], v[128:131], v[80:83], 0
    v_mfma_f32_16x16x32_bf16 v[20:23], v[128:131], v[84:87], 0
    buffer_load_dwordx4 v[152:155], v149, s[28:31], s22 offen offset:0
    v_mfma_f32_16x16x32_bf16 v[40:43], v[128:131], v[88:91], 0
    v_mfma_f32_16x16x32_bf16 v[60:63], v[128:131], v[92:95], 0
    ds_read_b128 v[128:131], v151 offset:40960
    v_mfma_f32_16x16x32_bf16 v[4:7], v[132:135], v[80:83], 0
    v_mfma_f32_16x16x32_bf16 v[24:27], v[132:135], v[84:87], 0
    buffer_load_dwordx4 v[156:159], v149, s[28:31], s22 offen offset:1024
    v_mfma_f32_16x16x32_bf16 v[44:47], v[132:135], v[88:91], 0
    v_mfma_f32_16x16x32_bf16 v[64:67], v[132:135], v[92:95], 0
    ds_read_b128 v[132:135], v151 offset:41984
    v_mfma_f32_16x16x32_bf16 v[8:11], v[136:139], v[80:83], 0
    v_mfma_f32_16x16x32_bf16 v[28:31], v[136:139], v[84:87], 0
    buffer_load_dwordx4 v[160:163], v149, s[28:31], s22 offen offset:2048
    v_mfma_f32_16x16x32_bf16 v[48:51], v[136:139], v[88:91], 0
    v_mfma_f32_16x16x32_bf16 v[68:71], v[136:139], v[92:95], 0
    ds_read_b128 v[136:139], v151 offset:43008
    v_mfma_f32_16x16x32_bf16 v[12:15], v[140:143], v[80:83], 0
    v_mfma_f32_16x16x32_bf16 v[32:35], v[140:143], v[84:87], 0
    buffer_load_dwordx4 v[164:167], v149, s[28:31], s22 offen offset:3072
    s_add_u32 s22, s22, 4096
    s_add_u32 s26, s26, 1
    s_cmp_eq_u32 s26, s48
    s_cselect_b32 s60, s62, 0
    s_cselect_b32 s26, 0, s26
    s_sub_u32 s22, s22, s60
    v_mfma_f32_16x16x32_bf16 v[52:55], v[140:143], v[88:91], 0
    v_mfma_f32_16x16x32_bf16 v[72:75], v[140:143], v[92:95], 0
    ds_read_b128 v[140:143], v151 offset:44032
    s_waitcnt lgkmcnt(4)
    v_mfma_f32_16x16x32_bf16 v[16:19], v[144:147], v[80:83], 0
    s_add_u32 m0, s24, 81920
    s_nop 0
    buffer_load_dwordx4 v149, s[28:31], s23 offen offset:0 lds
    v_mfma_f32_16x16x32_bf16 v[36:39], v[144:147], v[84:87], 0
    buffer_load_dwordx4 v149, s[28:31], s23 offen offset:1024 lds
    v_mfma_f32_16x16x32_bf16 v[56:59], v[144:147], v[88:91], 0
    buffer_load_dwordx4 v149, s[28:31], s23 offen offset:2048 lds
    v_mfma_f32_16x16x32_bf16 v[76:79], v[144:147], v[92:95], 0
    buffer_load_dwordx4 v149, s[28:31], s23 offen offset:3072 lds
    ds_read_b128 v[144:147], v151 offset:45056
    s_add_u32 m0, s24, 86016
    s_add_u32 s60, s23, 4096
    buffer_load_dwordx4 v149, s[28:31], s60 offen lds
    s_add_u32 s23, s23, 5120
    s_add_u32 s27, s27, 1
    s_cmp_eq_u32 s27, s48
    s_cselect_b32 s60, s63, 0
    s_cselect_b32 s27, 0, s27
    s_sub_u32 s23, s23, s60
    s_waitcnt vmcnt(13) lgkmcnt(1)
    v_mfma_f32_16x16x32_bf16 v[0:3], v[128:131], v[96:99], v[0:3]
    v_mfma_f32_16x16x32_bf16 v[20:23], v[128:131], v[100:103], v[20:23]
    buffer_load_dwordx4 v[80:83], v149, s[28:31], s22 offen offset:0
    v_mfma_f32_16x16x32_bf16 v[40:43], v[128:131], v[104:107], v[40:43]
    v_mfma_f32_16x16x32_bf16 v[60:63], v[128:131], v[108:111], v[60:63]
    ds_read_b128 v[128:131], v150 offset:0
    v_mfma_f32_16x16x32_bf16 v[4:7], v[132:135], v[96:99], v[4:7]
    v_mfma_f32_16x16x32_bf16 v[24:27], v[132:135], v[100:103], v[24:27]
    buffer_load_dwordx4 v[84:87], v149, s[28:31], s22 offen offset:1024
    v_mfma_f32_16x16x32_bf16 v[44:47], v[132:135], v[104:107], v[44:47]
    v_mfma_f32_16x16x32_bf16 v[64:67], v[132:135], v[108:111], v[64:67]
    ds_read_b128 v[132:135], v150 offset:1024
    v_mfma_f32_16x16x32_bf16 v[8:11], v[136:139], v[96:99], v[8:11]
    v_mfma_f32_16x16x32_bf16 v[28:31], v[136:139], v[100:103], v[28:31]
    buffer_load_dwordx4 v[88:91], v149, s[28:31], s22 offen offset:2048
    v_mfma_f32_16x16x32_bf16 v[48:51], v[136:139], v[104:107], v[48:51]
    v_mfma_f32_16x16x32_bf16 v[68:71], v[136:139], v[108:111], v[68:71]
    ds_read_b128 v[136:139], v150 offset:2048
    v_mfma_f32_16x16x32_bf16 v[12:15], v[140:143], v[96:99], v[12:15]
    v_mfma_f32_16x16x32_bf16 v[32:35], v[140:143], v[100:103], v[32:35]
    buffer_load_dwordx4 v[92:95], v149, s[28:31], s22 offen offset:3072
    s_add_u32 s22, s22, 4096
    s_add_u32 s26, s26, 1
    s_cmp_eq_u32 s26, s48
    s_cselect_b32 s60, s62, 0
    s_cselect_b32 s26, 0, s26
    s_sub_u32 s22, s22, s60
    v_mfma_f32_16x16x32_bf16 v[52:55], v[140:143], v[104:107], v[52:55]
    v_mfma_f32_16x16x32_bf16 v[72:75], v[140:143], v[108:111], v[72:75]
    ds_read_b128 v[140:143], v150 offset:3072
    s_waitcnt lgkmcnt(4)
    v_mfma_f32_16x16x32_bf16 v[16:19], v[144:147], v[96:99], v[16:19]
    s_add_u32 m0, s24, 122880
    s_nop 0
    buffer_load_dwordx4 v149, s[28:31], s23 offen offset:0 lds
    v_mfma_f32_16x16x32_bf16 v[36:39], v[144:147], v[100:103], v[36:39]
    buffer_load_dwordx4 v149, s[28:31], s23 offen offset:1024 lds
    v_mfma_f32_16x16x32_bf16 v[56:59], v[144:147], v[104:107], v[56:59]
    buffer_load_dwordx4 v149, s[28:31], s23 offen offset:2048 lds
    v_mfma_f32_16x16x32_bf16 v[76:79], v[144:147], v[108:111], v[76:79]
    buffer_load_dwordx4 v149, s[28:31], s23 offen offset:3072 lds
    ds_read_b128 v[144:147], v150 offset:4096
    s_add_u32 m0, s24, 126976
    s_add_u32 s60, s23, 4096
    buffer_load_dwordx4 v149, s[28:31], s60 offen lds
    s_add_u32 s23, s23, 5120
    s_add_u32 s27, s27, 1
    s_cmp_eq_u32 s27, s48
    s_cselect_b32 s60, s63, 0
    s_cselect_b32 s27, 0, s27
    s_sub_u32 s23, s23, s60
    s_waitcnt vmcnt(18) lgkmcnt(1)
    v_mfma_f32_16x16x32_bf16 v[0:3], v[128:131], v[112:115], v[0:3]
    v_mfma_f32_16x16x32_bf16 v[20:23], v[128:131], v[116:119], v[20:23]
    buffer_load_dwordx4 v[96:99], v149, s[28:31], s22 offen offset:0
    v_mfma_f32_16x16x32_bf16 v[40:43], v[128:131], v[120:123], v[40:43]
    v_mfma_f32_16x16x32_bf16 v[60:63], v[128:131], v[124:127], v[60:63]
    ds_read_b128 v[128:131], v150 offset:40960
    v_mfma_f32_16x16x32_bf16 v[4:7], v[132:135], v[112:115], v[4:7]
    v_mfma_f32_16x16x32_bf16 v[24:27], v[132:135], v[116:119], v[24:27]
    buffer_load_dwordx4 v[100:103], v149, s[28:31], s22 offen offset:1024
    v_mfma_f32_16x16x32_bf16 v[44:47], v[132:135], v[120:123], v[44:47]
    v_mfma_f32_16x16x32_bf16 v[64:67], v[132:135], v[124:127], v[64:67]
    ds_read_b128 v[132:135], v150 offset:41984
    v_mfma_f32_16x16x32_bf16 v[8:11], v[136:139], v[112:115], v[8:11]
    v_mfma_f32_16x16x32_bf16 v[28:31], v[136:139], v[116:119], v[28:31]
    buffer_load_dwordx4 v[104:107], v149, s[28:31], s22 offen offset:2048
    v_mfma_f32_16x16x32_bf16 v[48:51], v[136:139], v[120:123], v[48:51]
    v_mfma_f32_16x16x32_bf16 v[68:71], v[136:139], v[124:127], v[68:71]
    ds_read_b128 v[136:139], v150 offset:43008
    v_mfma_f32_16x16x32_bf16 v[12:15], v[140:143], v[112:115], v[12:15]
    v_mfma_f32_16x16x32_bf16 v[32:35], v[140:143], v[116:119], v[32:35]
    buffer_load_dwordx4 v[108:111], v149, s[28:31], s22 offen offset:3072
    s_add_u32 s22, s22, 4096
    s_add_u32 s26, s26, 1
    s_cmp_eq_u32 s26, s48
    s_cselect_b32 s60, s62, 0
    s_cselect_b32 s26, 0, s26
    s_sub_u32 s22, s22, s60
    v_mfma_f32_16x16x32_bf16 v[52:55], v[140:143], v[120:123], v[52:55]
    v_mfma_f32_16x16x32_bf16 v[72:75], v[140:143], v[124:127], v[72:75]
    ds_read_b128 v[140:143], v150 offset:44032
    s_waitcnt lgkmcnt(4)
    v_mfma_f32_16x16x32_bf16 v[16:19], v[144:147], v[112:115], v[16:19]
    s_add_u32 m0, s24, 0
    s_nop 0
    buffer_load_dwordx4 v149, s[28:31], s23 offen offset:0 lds
    v_mfma_f32_16x16x32_bf16 v[36:39], v[144:147], v[116:119], v[36:39]
    buffer_load_dwordx4 v149, s[28:31], s23 offen offset:1024 lds
    v_mfma_f32_16x16x32_bf16 v[56:59], v[144:147], v[120:123], v[56:59]
    buffer_load_dwordx4 v149, s[28:31], s23 offen offset:2048 lds
    v_mfma_f32_16x16x32_bf16 v[76:79], v[144:147], v[124:127], v[76:79]
    buffer_load_dwordx4 v149, s[28:31], s23 offen offset:3072 lds
    ds_read_b128 v[144:147], v150 offset:45056
    s_add_u32 m0, s24, 4096
    s_add_u32 s60, s23, 4096
    buffer_load_dwordx4 v149, s[28:31], s60 offen lds
    s_add_u32 s23, s23, 5120
    s_add_u32 s27, s27, 1
    s_cmp_eq_u32 s27, s48
    s_cselect_b32 s60, s63, 0
    s_cselect_b32 s27, 0, s27
    s_sub_u32 s23, s23, s60
    s_waitcnt vmcnt(18) lgkmcnt(1)
    v_mfma_f32_16x16x32_bf16 v[0:3], v[128:131], v[152:155], v[0:3]
    v_mfma_f32_16x16x32_bf16 v[20:23], v[128:131], v[156:159], v[20:23]
    buffer_load_dwordx4 v[112:115], v149, s[28:31], s22 offen offset:0
    v_mfma_f32_16x16x32_bf16 v[40:43], v[128:131], v[160:163], v[40:43]
    v_mfma_f32_16x16x32_bf16 v[60:63], v[128:131], v[164:167], v[60:63]
    ds_read_b128 v[128:131], v151 offset:0
    v_mfma_f32_16x16x32_bf16 v[4:7], v[132:135], v[152:155], v[4:7]
    v_mfma_f32_16x16x32_bf16 v[24:27], v[132:135], v[156:159], v[24:27]
    buffer_load_dwordx4 v[116:119], v149, s[28:31], s22 offen offset:1024
    v_mfma_f32_16x16x32_bf16 v[44:47], v[132:135], v[160:163], v[44:47]
    v_mfma_f32_16x16x32_bf16 v[64:67], v[132:135], v[164:167], v[64:67]
    ds_read_b128 v[132:135], v151 offset:1024
    v_mfma_f32_16x16x32_bf16 v[8:11], v[136:139], v[152:155], v[8:11]
    v_mfma_f32_16x16x32_bf16 v[28:31], v[136:139], v[156:159], v[28:31]
    buffer_load_dwordx4 v[120:123], v149, s[28:31], s22 offen offset:2048
    v_mfma_f32_16x16x32_bf16 v[48:51], v[136:139], v[160:163], v[48:51]
    v_mfma_f32_16x16x32_bf16 v[68:71], v[136:139], v[164:167], v[68:71]
    ds_read_b128 v[136:139], v151 offset:2048
    v_mfma_f32_16x16x32_bf16 v[12:15], v[140:143], v[152:155], v[12:15]
    v_mfma_f32_16x16x32_bf16 v[32:35], v[140:143], v[156:159], v[32:35]
    buffer_load_dwordx4 v[124:127], v149, s[28:31], s22 offen offset:3072
    s_add_u32 s22, s22, 4096
    s_add_u32 s26, s26, 1
    s_cmp_eq_u32 s26, s48
    s_cselect_b32 s60, s62, 0
    s_cselect_b32 s26, 0, s26
    s_sub_u32 s22, s22, s60
    v_mfma_f32_16x16x32_bf16 v[52:55], v[140:143], v[160:163], v[52:55]
    v_mfma_f32_16x16x32_bf16 v[72:75], v[140:143], v[164:167], v[72:75]
    ds_read_b128 v[140:143], v151 offset:3072
    s_waitcnt lgkmcnt(4)
    v_mfma_f32_16x16x32_bf16 v[16:19], v[144:147], v[152:155], v[16:19]
    s_add_u32 m0, s24, 40960
    s_nop 0
    buffer_load_dwordx4 v149, s[28:31], s23 offen offset:0 lds
    v_mfma_f32_16x16x32_bf16 v[36:39], v[144:147], v[156:159], v[36:39]
    buffer_load_dwordx4 v149, s[28:31], s23 offen offset:1024 lds
    v_mfma_f32_16x16x32_bf16 v[56:59], v[144:147], v[160:163], v[56:59]
    buffer_load_dwordx4 v149, s[28:31], s23 offen offset:2048 lds
    v_mfma_f32_16x16x32_bf16 v[76:79], v[144:147], v[164:167], v[76:79]
    buffer_load_dwordx4 v149, s[28:31], s23 offen offset:3072 lds
    ds_read_b128 v[144:147], v151 offset:4096
    s_add_u32 m0, s24, 45056
    s_add_u32 s60, s23, 4096
    buffer_load_dwordx4 v149, s[28:31], s60 offen lds
    s_add_u32 s23, s23, 5120
    s_add_u32 s27, s27, 1
    s_cmp_eq_u32 s27, s48
    s_cselect_b32 s60, s63, 0
    s_cselect_b32 s27, 0, s27
    s_sub_u32 s23, s23, s60
    s_waitcnt vmcnt(18) lgkmcnt(1)
    v_mfma_f32_16x16x32_bf16 v[0:3], v[128:131], v[80:83], v[0:3]
    v_mfma_f32_16x16x32_bf16 v[20:23], v[128:131], v[84:87], v[20:23]
    buffer_load_dwordx4 v[152:155], v149, s[28:31], s22 offen offset:0
    v_mfma_f32_16x16x32_bf16 v[40:43], v[128:131], v[88:91], v[40:43]
    v_mfma_f32_16x16x32_bf16 v[60:63], v[128:131], v[92:95], v[60:63]
    ds_read_b128 v[128:131], v151 offset:40960
    v_mfma_f32_16x16x32_bf16 v[4:7], v[132:135], v[80:83], v[4:7]
    v_mfma_f32_16x16x32_bf16 v[24:27], v[132:135], v[84:87], v[24:27]
    buffer_load_dwordx4 v[156:159], v149, s[28:31], s22 offen offset:1024
    v_mfma_f32_16x16x32_bf16 v[44:47], v[132:135], v[88:91], v[44:47]
    v_mfma_f32_16x16x32_bf16 v[64:67], v[132:135], v[92:95], v[64:67]
    ds_read_b128 v[132:135], v151 offset:41984
    v_mfma_f32_16x16x32_bf16 v[8:11], v[136:139], v[80:83], v[8:11]
    v_mfma_f32_16x16x32_bf16 v[28:31], v[136:139], v[84:87], v[28:31]
    buffer_load_dwordx4 v[160:163], v149, s[28:31], s22 offen offset:2048
    v_mfma_f32_16x16x32_bf16 v[48:51], v[136:139], v[88:91], v[48:51]
    v_mfma_f32_16x16x32_bf16 v[68:71], v[136:139], v[92:95], v[68:71]
    ds_read_b128 v[136:139], v151 offset:43008
    v_mfma_f32_16x16x32_bf16 v[12:15], v[140:143], v[80:83], v[12:15]
    v_mfma_f32_16x16x32_bf16 v[32:35], v[140:143], v[84:87], v[32:35]
    buffer_load_dwordx4 v[164:167], v149, s[28:31], s22 offen offset:3072
    s_add_u32 s22, s22, 4096
    s_add_u32 s26, s26, 1
    s_cmp_eq_u32 s26, s48
    s_cselect_b32 s60, s62, 0
    s_cselect_b32 s26, 0, s26
    s_sub_u32 s22, s22, s60
    v_mfma_f32_16x16x32_bf16 v[52:55], v[140:143], v[88:91], v[52:55]
    v_mfma_f32_16x16x32_bf16 v[72:75], v[140:143], v[92:95], v[72:75]
    ds_read_b128 v[140:143], v151 offset:44032
    s_waitcnt lgkmcnt(4)
    v_mfma_f32_16x16x32_bf16 v[16:19], v[144:147], v[80:83], v[16:19]
    s_add_u32 m0, s24, 81920
    s_nop 0
    buffer_load_dwordx4 v149, s[28:31], s23 offen offset:0 lds
    v_mfma_f32_16x16x32_bf16 v[36:39], v[144:147], v[84:87], v[36:39]
    buffer_load_dwordx4 v149, s[28:31], s23 offen offset:1024 lds
    v_mfma_f32_16x16x32_bf16 v[56:59], v[144:147], v[88:91], v[56:59]
    buffer_load_dwordx4 v149, s[28:31], s23 offen offset:2048 lds
    v_mfma_f32_16x16x32_bf16 v[76:79], v[144:147], v[92:95], v[76:79]
    buffer_load_dwordx4 v149, s[28:31], s23 offen offset:3072 lds
    ds_read_b128 v[144:147], v151 offset:45056
    s_add_u32 m0, s24, 86016
    s_add_u32 s60, s23, 4096
    buffer_load_dwordx4 v149, s[28:31], s60 offen lds
    s_add_u32 s23, s23, 5120
    s_add_u32 s27, s27, 1
    s_cmp_eq_u32 s27, s48
    s_cselect_b32 s60, s63, 0
    s_cselect_b32 s27, 0, s27
    s_sub_u32 s23, s23, s60
    s_waitcnt vmcnt(18) lgkmcnt(1)
    v_mfma_f32_16x16x32_bf16 v[0:3], v[128:131], v[96:99], v[0:3]
    v_mfma_f32_16x16x32_bf16 v[20:23], v[128:131], v[100:103], v[20:23]
    buffer_load_dwordx4 v[80:83], v149, s[28:31], s22 offen offset:0
    v_mfma_f32_16x16x32_bf16 v[40:43], v[128:131], v[104:107], v[40:43]
    v_mfma_f32_16x16x32_bf16 v[60:63], v[128:131], v[108:111], v[60:63]
    ds_read_b128 v[128:131], v150 offset:0
    v_mfma_f32_16x16x32_bf16 v[4:7], v[132:135], v[96:99], v[4:7]
    v_mfma_f32_16x16x32_bf16 v[24:27], v[132:135], v[100:103], v[24:27]
    buffer_load_dwordx4 v[84:87], v149, s[28:31], s22 offen offset:1024
    v_mfma_f32_16x16x32_bf16 v[44:47], v[132:135], v[104:107], v[44:47]
    v_mfma_f32_16x16x32_bf16 v[64:67], v[132:135], v[108:111], v[64:67]
    ds_read_b128 v[132:135], v150 offset:1024
    v_mfma_f32_16x16x32_bf16 v[8:11], v[136:139], v[96:99], v[8:11]
    v_mfma_f32_16x16x32_bf16 v[28:31], v[136:139], v[100:103], v[28:31]
    buffer_load_dwordx4 v[88:91], v149, s[28:31], s22 offen offset:2048
    v_mfma_f32_16x16x32_bf16 v[48:51], v[136:139], v[104:107], v[48:51]
    v_mfma_f32_16x16x32_bf16 v[68:71], v[136:139], v[108:111], v[68:71]
    ds_read_b128 v[136:139], v150 offset:2048
    v_mfma_f32_16x16x32_bf16 v[12:15], v[140:143], v[96:99], v[12:15]
    v_mfma_f32_16x16x32_bf16 v[32:35], v[140:143], v[100:103], v[32:35]
    buffer_load_dwordx4 v[92:95], v149, s[28:31], s22 offen offset:3072
    s_add_u32 s22, s22, 4096
    s_add_u32 s26, s26, 1
    s_cmp_eq_u32 s26, s48
    s_cselect_b32 s60, s62, 0
    s_cselect_b32 s26, 0, s26
    s_sub_u32 s22, s22, s60
    v_mfma_f32_16x16x32_bf16 v[52:55], v[140:143], v[104:107], v[52:55]
    v_mfma_f32_16x16x32_bf16 v[72:75], v[140:143], v[108:111], v[72:75]
    ds_read_b128 v[140:143], v150 offset:3072
    s_waitcnt lgkmcnt(4)
    v_mfma_f32_16x16x32_bf16 v[16:19], v[144:147], v[96:99], v[16:19]
    v_mfma_f32_16x16x32_bf16 v[36:39], v[144:147], v[100:103], v[36:39]
    v_mfma_f32_16x16x32_bf16 v[56:59], v[144:147], v[104:107], v[56:59]
    v_mfma_f32_16x16x32_bf16 v[76:79], v[144:147], v[108:111], v[76:79]
    ds_read_b128 v[144:147], v150 offset:4096
    s_waitcnt vmcnt(13) lgkmcnt(1)
    v_mfma_f32_16x16x32_bf16 v[0:3], v[128:131], v[112:115], v[0:3]
    v_mfma_f32_16x16x32_bf16 v[20:23], v[128:131], v[116:119], v[20:23]
    v_mfma_f32_16x16x32_bf16 v[40:43], v[128:131], v[120:123], v[40:43]
    v_mfma_f32_16x16x32_bf16 v[60:63], v[128:131], v[124:127], v[60:63]
    ds_read_b128 v[128:131], v150 offset:40960
    v_mfma_f32_16x16x32_bf16 v[4:7], v[132:135], v[112:115], v[4:7]
    v_mfma_f32_16x16x32_bf16 v[24:27], v[132:135], v[116:119], v[24:27]
    v_mfma_f32_16x16x32_bf16 v[44:47], v[132:135], v[120:123], v[44:47]
    v_mfma_f32_16x16x32_bf16 v[64:67], v[132:135], v[124:127], v[64:67]
    ds_read_b128 v[132:135], v150 offset:41984
    v_mfma_f32_16x16x32_bf16 v[8:11], v[136:139], v[112:115], v[8:11]
    v_mfma_f32_16x16x32_bf16 v[28:31], v[136:139], v[116:119], v[28:31]
    v_mfma_f32_16x16x32_bf16 v[48:51], v[136:139], v[120:123], v[48:51]
    v_mfma_f32_16x16x32_bf16 v[68:71], v[136:139], v[124:127], v[68:71]
    ds_read_b128 v[136:139], v150 offset:43008
    v_mfma_f32_16x16x32_bf16 v[12:15], v[140:143], v[112:115], v[12:15]
    v_mfma_f32_16x16x32_bf16 v[32:35], v[140:143], v[116:119], v[32:35]
    v_mfma_f32_16x16x32_bf16 v[52:55], v[140:143], v[120:123], v[52:55]
    v_mfma_f32_16x16x32_bf16 v[72:75], v[140:143], v[124:127], v[72:75]
    ds_read_b128 v[140:143], v150 offset:44032
    s_waitcnt lgkmcnt(4)
    v_mfma_f32_16x16x32_bf16 v[16:19], v[144:147], v[112:115], v[16:19]
    v_mfma_f32_16x16x32_bf16 v[36:39], v[144:147], v[116:119], v[36:39]
    v_mfma_f32_16x16x32_bf16 v[56:59], v[144:147], v[120:123], v[56:59]
    v_mfma_f32_16x16x32_bf16 v[76:79], v[144:147], v[124:127], v[76:79]
    ds_read_b128 v[144:147], v150 offset:45056
    s_waitcnt vmcnt(4) lgkmcnt(1)
    v_mfma_f32_16x16x32_bf16 v[0:3], v[128:131], v[152:155], v[0:3]
    v_mfma_f32_16x16x32_bf16 v[20:23], v[128:131], v[156:159], v[20:23]
    v_mfma_f32_16x16x32_bf16 v[40:43], v[128:131], v[160:163], v[40:43]
    v_mfma_f32_16x16x32_bf16 v[60:63], v[128:131], v[164:167], v[60:63]
    ds_read_b128 v[128:131], v151 offset:0
    v_mfma_f32_16x16x32_bf16 v[4:7], v[132:135], v[152:155], v[4:7]
    v_mfma_f32_16x16x32_bf16 v[24:27], v[132:135], v[156:159], v[24:27]
    v_mfma_f32_16x16x32_bf16 v[44:47], v[132:135], v[160:163], v[44:47]
    v_mfma_f32_16x16x32_bf16 v[64:67], v[132:135], v[164:167], v[64:67]
    ds_read_b128 v[132:135], v151 offset:1024
    v_mfma_f32_16x16x32_bf16 v[8:11], v[136:139], v[152:155], v[8:11]
    v_mfma_f32_16x16x32_bf16 v[28:31], v[136:139], v[156:159], v[28:31]
    v_mfma_f32_16x16x32_bf16 v[48:51], v[136:139], v[160:163], v[48:51]
    v_mfma_f32_16x16x32_bf16 v[68:71], v[136:139], v[164:167], v[68:71]
    ds_read_b128 v[136:139], v151 offset:2048
    v_mfma_f32_16x16x32_bf16 v[12:15], v[140:143], v[152:155], v[12:15]
    v_mfma_f32_16x16x32_bf16 v[32:35], v[140:143], v[156:159], v[32:35]
    v_mfma_f32_16x16x32_bf16 v[52:55], v[140:143], v[160:163], v[52:55]
    v_mfma_f32_16x16x32_bf16 v[72:75], v[140:143], v[164:167], v[72:75]
    ds_read_b128 v[140:143], v151 offset:3072
    s_waitcnt lgkmcnt(4)
    v_mfma_f32_16x16x32_bf16 v[16:19], v[144:147], v[152:155], v[16:19]
    v_mfma_f32_16x16x32_bf16 v[36:39], v[144:147], v[156:159], v[36:39]
    v_mfma_f32_16x16x32_bf16 v[56:59], v[144:147], v[160:163], v[56:59]
    v_mfma_f32_16x16x32_bf16 v[76:79], v[144:147], v[164:167], v[76:79]
    ds_read_b128 v[144:147], v151 offset:4096
    s_waitcnt vmcnt(0) lgkmcnt(1)
    v_mfma_f32_16x16x32_bf16 v[0:3], v[128:131], v[80:83], v[0:3]
    v_mfma_f32_16x16x32_bf16 v[20:23], v[128:131], v[84:87], v[20:23]
    v_mfma_f32_16x16x32_bf16 v[40:43], v[128:131], v[88:91], v[40:43]
    v_mfma_f32_16x16x32_bf16 v[60:63], v[128:131], v[92:95], v[60:63]
    v_mfma_f32_16x16x32_bf16 v[4:7], v[132:135], v[80:83], v[4:7]
    v_mfma_f32_16x16x32_bf16 v[24:27], v[132:135], v[84:87], v[24:27]
    v_mfma_f32_16x16x32_bf16 v[44:47], v[132:135], v[88:91], v[44:47]
    v_mfma_f32_16x16x32_bf16 v[64:67], v[132:135], v[92:95], v[64:67]
    v_mfma_f32_16x16x32_bf16 v[8:11], v[136:139], v[80:83], v[8:11]
    v_mfma_f32_16x16x32_bf16 v[28:31], v[136:139], v[84:87], v[28:31]
    v_mfma_f32_16x16x32_bf16 v[48:51], v[136:139], v[88:91], v[48:51]
    v_mfma_f32_16x16x32_bf16 v[68:71], v[136:139], v[92:95], v[68:71]
    v_mfma_f32_16x16x32_bf16 v[12:15], v[140:143], v[80:83], v[12:15]
    v_mfma_f32_16x16x32_bf16 v[32:35], v[140:143], v[84:87], v[32:35]
    v_mfma_f32_16x16x32_bf16 v[52:55], v[140:143], v[88:91], v[52:55]
    v_mfma_f32_16x16x32_bf16 v[72:75], v[140:143], v[92:95], v[72:75]
    s_waitcnt lgkmcnt(0)
    v_mfma_f32_16x16x32_bf16 v[16:19], v[144:147], v[80:83], v[16:19]
    v_mfma_f32_16x16x32_bf16 v[36:39], v[144:147], v[84:87], v[36:39]
    v_mfma_f32_16x16x32_bf16 v[56:59], v[144:147], v[88:91], v[56:59]
    v_mfma_f32_16x16x32_bf16 v[76:79], v[144:147], v[92:95], v[76:79]
gated_mix__sliding_local_dilated__dense_activation_mish__prompt_kernel_epi2:
    ds_write_b128 v150, v[0:3] offset:0
    ds_write_b128 v150, v[4:7] offset:1024
    ds_write_b128 v150, v[8:11] offset:2048
    ds_write_b128 v150, v[12:15] offset:3072
    s_nop 0
    ds_write_b128 v150, v[16:19] offset:4096
    ds_write_b128 v150, v[20:23] offset:40960
    ds_write_b128 v150, v[24:27] offset:41984
    ds_write_b128 v150, v[28:31] offset:43008
    ds_write_b128 v150, v[32:35] offset:44032
    ds_write_b128 v150, v[36:39] offset:45056
    ds_write_b128 v151, v[40:43] offset:0
    ds_write_b128 v151, v[44:47] offset:1024
    ds_write_b128 v151, v[48:51] offset:2048
    ds_write_b128 v151, v[52:55] offset:3072
    ds_write_b128 v151, v[56:59] offset:4096
    ds_write_b128 v151, v[60:63] offset:40960
    ds_write_b128 v151, v[64:67] offset:41984
    ds_write_b128 v151, v[68:71] offset:43008
    ds_write_b128 v151, v[72:75] offset:44032
    ds_write_b128 v151, v[76:79] offset:45056
    s_lshr_b32 s60, s50, 1
    s_mul_i32 s60, s60, 40960
    s_and_b32 s61, s50, 1
    s_mul_i32 s62, s61, 3072
    s_add_u32 s60, s60, s62
    v_add_u32 v150, s60, v149
    v_lshrrev_b32 v153, 4, v149
    s_waitcnt lgkmcnt(0)
    s_barrier
    ds_read_b128 v[0:3], v150 offset:0
    ds_read_b128 v[4:7], v150 offset:5120
    ds_read_b128 v[8:11], v150 offset:10240
    ds_read_b128 v[12:15], v150 offset:15360
    ds_read_b128 v[16:19], v150 offset:20480
    ds_read_b128 v[20:23], v150 offset:25600
    ds_read_b128 v[24:27], v150 offset:30720
    ds_read_b128 v[28:31], v150 offset:35840
    ds_read_b128 v[32:35], v150 offset:1024
    ds_read_b128 v[36:39], v150 offset:6144
    ds_read_b128 v[40:43], v150 offset:11264
    ds_read_b128 v[44:47], v150 offset:16384
    ds_read_b128 v[48:51], v150 offset:21504
    ds_read_b128 v[52:55], v150 offset:26624
    ds_read_b128 v[56:59], v150 offset:31744
    ds_read_b128 v[60:63], v150 offset:36864
    s_cmp_eq_u32 s61, 1
    s_cbranch_scc1 gated_mix__sliding_local_dilated__dense_activation_mish__prompt_kernel_rd_done
    ds_read_b128 v[64:67], v150 offset:2048
    ds_read_b128 v[68:71], v150 offset:7168
    ds_read_b128 v[72:75], v150 offset:12288
    ds_read_b128 v[76:79], v150 offset:17408
    ds_read_b128 v[80:83], v150 offset:22528
    ds_read_b128 v[84:87], v150 offset:27648
    ds_read_b128 v[88:91], v150 offset:32768
    ds_read_b128 v[92:95], v150 offset:37888
gated_mix__sliding_local_dilated__dense_activation_mish__prompt_kernel_rd_done:
    s_waitcnt vmcnt(0)
    v_sub_f32 v151, 1.0, v148
    v_cvt_pk_bf16_f32 v151, v151, v151
    v_lshlrev_b32 v151, 16, v151
    s_lshl_b32 s60, s20, 6
    s_lshr_b32 s62, s50, 1
    s_lshl_b32 s62, s62, 4
    s_add_u32 s60, s60, s62
    v_and_b32 v154, 15, v153
    v_add_u32 v154, s60, v154
    v_lshrrev_b32 v156, 4, v153
    v_mul_u32_u24 v154, 1280, v154
    v_lshl_add_u32 v154, v156, 3, v154
    s_mul_i32 s60, s21, 160
    s_mul_i32 s62, s61, 96
    s_add_u32 s60, s60, s62
    s_mov_b32 s62, 0xffff0000
    s_waitcnt lgkmcnt(0)
    v_pk_add_f32 v[0:1], v[0:1], v[4:5]
    v_pk_add_f32 v[8:9], v[8:9], v[12:13]
    v_pk_add_f32 v[16:17], v[16:17], v[20:21]
    v_pk_add_f32 v[24:25], v[24:25], v[28:29]
    v_pk_add_f32 v[2:3], v[2:3], v[6:7]
    v_pk_add_f32 v[10:11], v[10:11], v[14:15]
    v_pk_add_f32 v[18:19], v[18:19], v[22:23]
    v_pk_add_f32 v[26:27], v[26:27], v[30:31]
    v_pk_add_f32 v[8:9], v[8:9], v[16:17]
    v_pk_add_f32 v[10:11], v[10:11], v[18:19]
    v_pk_add_f32 v[8:9], v[8:9], v[24:25]
    v_pk_add_f32 v[10:11], v[10:11], v[26:27]
    v_cvt_pk_bf16_f32 v16, v0, v1
    v_cvt_pk_bf16_f32 v20, v8, v9
    v_lshlrev_b32 v0, 16, v16
    v_and_b32 v1, s62, v16
    v_lshlrev_b32 v8, 16, v20
    v_and_b32 v9, s62, v20
    v_mul_f32 v0, v148, v0
    v_mul_f32 v1, v148, v1
    v_fmac_f32 v0, v151, v8
    v_fmac_f32 v1, v151, v9
    v_cvt_pk_bf16_f32 v156, v0, v1
    v_cvt_pk_bf16_f32 v18, v2, v3
    v_cvt_pk_bf16_f32 v22, v10, v11
    v_lshlrev_b32 v2, 16, v18
    v_and_b32 v3, s62, v18
    v_lshlrev_b32 v10, 16, v22
    v_and_b32 v11, s62, v22
    v_mul_f32 v2, v148, v2
    v_mul_f32 v3, v148, v3
    v_fmac_f32 v2, v151, v10
    v_fmac_f32 v3, v151, v11
    v_cvt_pk_bf16_f32 v157, v2, v3
    buffer_store_dwordx2 v[156:157], v154, s[36:39], s60 offen offset:0
    v_pk_add_f32 v[32:33], v[32:33], v[36:37]
    v_pk_add_f32 v[40:41], v[40:41], v[44:45]
    v_pk_add_f32 v[48:49], v[48:49], v[52:53]
    v_pk_add_f32 v[56:57], v[56:57], v[60:61]
    v_pk_add_f32 v[34:35], v[34:35], v[38:39]
    v_pk_add_f32 v[42:43], v[42:43], v[46:47]
    v_pk_add_f32 v[50:51], v[50:51], v[54:55]
    v_pk_add_f32 v[58:59], v[58:59], v[62:63]
    v_pk_add_f32 v[40:41], v[40:41], v[48:49]
    v_pk_add_f32 v[42:43], v[42:43], v[50:51]
    v_pk_add_f32 v[40:41], v[40:41], v[56:57]
    v_pk_add_f32 v[42:43], v[42:43], v[58:59]
    v_cvt_pk_bf16_f32 v48, v32, v33
    v_cvt_pk_bf16_f32 v52, v40, v41
    v_lshlrev_b32 v32, 16, v48
    v_and_b32 v33, s62, v48
    v_lshlrev_b32 v40, 16, v52
    v_and_b32 v41, s62, v52
    v_mul_f32 v32, v148, v32
    v_mul_f32 v33, v148, v33
    v_fmac_f32 v32, v151, v40
    v_fmac_f32 v33, v151, v41
    v_cvt_pk_bf16_f32 v158, v32, v33
    v_cvt_pk_bf16_f32 v50, v34, v35
    v_cvt_pk_bf16_f32 v54, v42, v43
    v_lshlrev_b32 v34, 16, v50
    v_and_b32 v35, s62, v50
    v_lshlrev_b32 v42, 16, v54
    v_and_b32 v43, s62, v54
    v_mul_f32 v34, v148, v34
    v_mul_f32 v35, v148, v35
    v_fmac_f32 v34, v151, v42
    v_fmac_f32 v35, v151, v43
    v_cvt_pk_bf16_f32 v159, v34, v35
    buffer_store_dwordx2 v[158:159], v154, s[36:39], s60 offen offset:32
    s_cmp_eq_u32 s61, 1
    s_cbranch_scc1 gated_mix__sliding_local_dilated__dense_activation_mish__prompt_kernel_fin
    v_pk_add_f32 v[64:65], v[64:65], v[68:69]
    v_pk_add_f32 v[72:73], v[72:73], v[76:77]
    v_pk_add_f32 v[80:81], v[80:81], v[84:85]
    v_pk_add_f32 v[88:89], v[88:89], v[92:93]
    v_pk_add_f32 v[66:67], v[66:67], v[70:71]
    v_pk_add_f32 v[74:75], v[74:75], v[78:79]
    v_pk_add_f32 v[82:83], v[82:83], v[86:87]
    v_pk_add_f32 v[90:91], v[90:91], v[94:95]
    v_pk_add_f32 v[72:73], v[72:73], v[80:81]
    v_pk_add_f32 v[74:75], v[74:75], v[82:83]
    v_pk_add_f32 v[72:73], v[72:73], v[88:89]
    v_pk_add_f32 v[74:75], v[74:75], v[90:91]
    v_cvt_pk_bf16_f32 v80, v64, v65
    v_cvt_pk_bf16_f32 v84, v72, v73
    v_lshlrev_b32 v64, 16, v80
    v_and_b32 v65, s62, v80
    v_lshlrev_b32 v72, 16, v84
    v_and_b32 v73, s62, v84
    v_mul_f32 v64, v148, v64
    v_mul_f32 v65, v148, v65
    v_fmac_f32 v64, v151, v72
    v_fmac_f32 v65, v151, v73
    v_cvt_pk_bf16_f32 v160, v64, v65
    v_cvt_pk_bf16_f32 v82, v66, v67
    v_cvt_pk_bf16_f32 v86, v74, v75
    v_lshlrev_b32 v66, 16, v82
    v_and_b32 v67, s62, v82
    v_lshlrev_b32 v74, 16, v86
    v_and_b32 v75, s62, v86
    v_mul_f32 v66, v148, v66
    v_mul_f32 v67, v148, v67
    v_fmac_f32 v66, v151, v74
    v_fmac_f32 v67, v151, v75
    v_cvt_pk_bf16_f32 v161, v66, v67
    buffer_store_dwordx2 v[160:161], v154, s[36:39], s60 offen offset:64
gated_mix__sliding_local_dilated__dense_activation_mish__prompt_kernel_fin:
gated_mix__sliding_local_dilated__dense_activation_mish__prompt_kernel_exit:
    s_endpgm

.section .rodata,"a"
.p2align 6
.amdhsa_kernel gated_mix__sliding_local_dilated__dense_activation_mish__prompt_kernel
  .amdhsa_next_free_vgpr 168
  .amdhsa_next_free_sgpr 102
  .amdhsa_accum_offset 168
  .amdhsa_group_segment_fixed_size 0
  .amdhsa_kernarg_size 88
  .amdhsa_user_sgpr_count 2
  .amdhsa_user_sgpr_kernarg_segment_ptr 1
  .amdhsa_system_sgpr_workgroup_id_x 1
.end_amdhsa_kernel
```
